```python
import torch

def _softmax(x, axis=-1):
    return torch.softmax(x, dim=axis)
def _gelu(x):
    return torch.nn.functional.gelu(x, approximate="tanh")
def _silu(x):
    return torch.nn.functional.silu(x)
def _sigmoid(x):
    return torch.sigmoid(x)
def _layernorm(x, axis=-1, eps=1e-5):
    m = x.mean(dim=axis, keepdim=True)
    v = x.var(dim=axis, keepdim=True, unbiased=False)
    return (x - m) / torch.sqrt(v + eps)
def _scatter_add(tgt, idx, src, axis=0):
    return tgt.clone().index_add_(axis, idx, src)
def _segment_sum(src, seg, n):
    out = torch.zeros((n,) + src.shape[1:], dtype=src.dtype)
    return out.index_add_(0, seg, src)
def _pad(x, pw):
    flat = tuple(v for pair in reversed(pw) for v in pair)
    return torch.nn.functional.pad(x, flat)

kernel_name = 'sequential_preLN__sliding_block_cached__swiglu_ffn__decode'

def setup_inputs():

    _w = (lambda a: (lambda t: t.to(torch.bfloat16) if t.is_floating_point() else t)(torch.as_tensor(a)))
    def _A_setup():
        B, Sq, D = 4, 1, 448
        Hq, Hkv, Sk, Dh = 16, 8, 4096, 256
        assert Hq % Hkv == 0, (Hq, Hkv)
        return {
            "x": _w((lambda *s: torch.randn(*s, dtype=torch.bfloat16) * 0.05)(B, Sq, D)),
            "k_cache": _w((lambda *s: torch.randn(*s, dtype=torch.bfloat16) * 3.2)(B, Hkv, Sk, Dh)),
            "v_cache": _w((lambda *s: torch.randn(*s, dtype=torch.bfloat16) * 0.4)(B, Hkv, Sk, Dh)),
            "wq": _w((lambda *s: torch.randn(*s, dtype=torch.bfloat16) * 3.2)(D, Hq * Dh) * (D ** -0.5)),
            "wo": _w((lambda *s: torch.randn(*s, dtype=torch.bfloat16) * 0.4)(Hq * Dh, D) * ((Hq * Dh) ** -0.5)),
        }
    _A_in = _A_setup()

    def _B_setup():
        B, S, D, F = 4, 1, 448, 1792
        return {
            "x": _w((lambda *s: torch.randn(*s, dtype=torch.bfloat16) * 0.05)(B, S, D)),
            "w_gate": _w((lambda *s: torch.randn(*s, dtype=torch.bfloat16) * 0.05)(D, F)),
            "w_up": _w((lambda *s: torch.randn(*s, dtype=torch.bfloat16) * 0.05)(D, F)),
            "w_down": _w((lambda *s: torch.randn(*s, dtype=torch.bfloat16) * 0.05)(F, D)),
        }
    _B_in = _B_setup()

    return {
        "A_x": _A_in["x"],
        "A_k_cache": _A_in["k_cache"],
        "A_v_cache": _A_in["v_cache"],
        "A_wq": _A_in["wq"],
        "A_wo": _A_in["wo"],
        "B_x": _B_in["x"],
        "B_w_gate": _B_in["w_gate"],
        "B_w_up": _B_in["w_up"],
        "B_w_down": _B_in["w_down"],
    }

def reference(A_x, A_k_cache, A_v_cache, A_wq, A_wo, B_x, B_w_gate, B_w_up, B_w_down):
    def _A_ref(x, k_cache, v_cache, wq, wo):
        B, Sq, D = x.shape
        Hq, Dh = 16, 256
        Hkv, Sk = k_cache.shape[1], k_cache.shape[2]
        W = min(4096, max(256, Sk // 4))
        rep = Hq // Hkv
        q = (lambda x, *d: x.permute(*d))((x @ wq).reshape(B, Sq, Hq, Dh), 0, 2, 1, 3)
        k = (lambda x, n, axis: torch.repeat_interleave(x, n, dim=axis))(k_cache[:, :, Sk - W:, :], rep, axis=1)
        v = (lambda x, n, axis: torch.repeat_interleave(x, n, dim=axis))(v_cache[:, :, Sk - W:, :], rep, axis=1)
        scores = torch.einsum("bhqd,bhkd->bhqk", q, k) * (Dh ** -0.5)
        p = _softmax(scores, axis=-1)
        o = torch.einsum("bhqk,bhkd->bhqd", p, v)
        return (lambda x, *d: x.permute(*d))(o, 0, 2, 1, 3).reshape(B, Sq, Hq * Dh) @ wo

    def _B_ref(x, w_gate, w_up, w_down):
        g = _silu(x @ w_gate)
        u = x @ w_up
        return (g * u) @ w_down

    x = A_x
    h = x + _A_ref(_layernorm(x, axis=-1), A_k_cache, A_v_cache, A_wq, A_wo)
    h2 = h + _B_ref(_layernorm(h, axis=-1), B_w_gate, B_w_up, B_w_down)
    return h2
```

```asm
; @launch grid=(256,1,1) block=(512,1,1) lds=158464
.amdgcn_target "amdgcn-amd-amdhsa--gfx950"
.text
.globl sequential_preLN__sliding_block_cached__swiglu_ffn__decode_kernel
.p2align 12
.type sequential_preLN__sliding_block_cached__swiglu_ffn__decode_kernel,@function
sequential_preLN__sliding_block_cached__swiglu_ffn__decode_kernel:
    s_cmp_ge_u32 s2, 256
    s_cbranch_scc1 L_END
    s_load_dwordx16 s[16:31], s[0:1], 0
    s_load_dwordx8 s[32:39], s[0:1], 64
    v_lshrrev_b32 v1, 6, v0
    v_and_b32 v0, 63, v0
    v_readfirstlane_b32 s3, v1
    s_lshr_b32 s5, s2, 3
    s_cmp_lg_u32 s3, 1
    s_cbranch_scc1 L_NOINIT
    s_getpc_b64 s[56:57]
L_PC:
    s_sub_u32 s56, s56, L_PC-sequential_preLN__sliding_block_cached__swiglu_ffn__decode_kernel
    s_subb_u32 s57, s57, 0
    v_and_b32 v6, 3, v0
    v_lshl_add_u32 v6, s5, 2, v6
    v_lshlrev_b32 v6, 7, v6
    v_min_u32 v6, L_END-sequential_preLN__sliding_block_cached__swiglu_ffn__decode_kernel, v6
    global_load_dword v47, v6, s[56:57]
    v_min_u32 v6, 39, v0
    v_lshlrev_b32 v6, 3, v6
    v_add_u32 v6, 158144, v6
    v_mov_b32 v12, 0
    v_mov_b32 v13, 0
    ds_write_b64 v6, v[12:13]
L_NOINIT:
    s_and_b32 s4, s2, 7
    s_lshr_b32 s6, s2, 6
    s_and_b32 s7, s5, 7
    s_lshl_b32 s10, s6, 3
    s_add_u32 s10, s10, s4
    s_lshl_b32 s9, s4, 2
    s_add_u32 s8, s9, s6
    s_and_b32 s11, s3, 3
    s_mov_b32 s66, 2
    s_cmp_lt_u32 s5, 29
    s_cselect_b32 s66, 1, s66
    s_cmp_lt_u32 s5, 22
    s_cselect_b32 s66, 3, s66
    s_cmp_lt_u32 s5, 8
    s_cselect_b32 s66, 0, s66
    s_lshr_b32 s70, s5, 2
    s_add_u32 s70, s70, s4
    s_and_b32 s70, s70, 3
    s_lshl_b32 s70, s70, 7
    s_cmp_lt_u32 s3, 4
    s_cbranch_scc1 L_SROLE
    v_lshrrev_b32 v13, 3, v0
    v_and_b32 v14, 7, v0
    v_lshrrev_b32 v15, 1, v13
    v_xor_b32 v1, v14, v15
    v_lshlrev_b32 v1, 4, v1
    v_lshl_add_u32 v1, v13, 9, v1
    v_xor_b32 v2, 64, v1
    v_add_u32 v2, 4096, v2
    v_lshlrev_b32 v3, 1, v15
    v_xor_b32 v3, v14, v3
    v_lshlrev_b32 v3, 4, v3
    v_lshl_add_u32 v3, v13, 9, v3
    v_mov_b32 v13, 158400
    s_lshl_b32 s12, s11, 14
    s_lshl_b32 s56, s10, 21
    s_add_u32 s56, s56, 0x180000
    s_lshl_b32 s57, s7, 16
    s_add_u32 s56, s56, s57
    s_lshl_b32 s63, s4, 1
    s_add_u32 s63, s63, s5
    s_and_b32 s63, s63, 15
    s_lshl_b32 s63, s63, 12
    s_and_b32 s62, s63, 0x2000
    s_or_b32 s62, s62, s70
    s_and_b32 s57, s63, 0x1000
    v_xor_b32 v1, s57, v1
    v_xor_b32 v2, s57, v2
    s_and_b32 s57, s63, 0xc000
    s_xor_b32 s57, s57, s12
    s_add_u32 s57, s56, s57
    s_lshl_b32 s58, s11, 7
    s_add_u32 s58, s58, s56
    s_waitcnt lgkmcnt(0)
    s_add_u32 s40, s18, s57
    s_addc_u32 s41, s19, 0
    s_mov_b32 s42, 16384
    s_mov_b32 s43, 0x20000
    s_cmp_lg_u32 s66, 0
    s_cbranch_scc0 L_K_Q
    s_mov_b32 m0, s12
    s_xor_b32 s15, s62, 0
    buffer_load_dwordx4 v1, s[40:43], s15 offen nt lds
    s_addk_i32 m0, 1024
    s_xor_b32 s15, s62, 0
    buffer_load_dwordx4 v2, s[40:43], s15 offen nt lds
    s_addk_i32 m0, 1024
    s_xor_b32 s15, s62, 128
    buffer_load_dwordx4 v1, s[40:43], s15 offen nt lds
    s_addk_i32 m0, 1024
    s_xor_b32 s15, s62, 128
    buffer_load_dwordx4 v2, s[40:43], s15 offen nt lds
    s_barrier
    s_branch L_KMAIN
L_K_Q:
    v_bfe_u32 v16, v0, 3, 2
    v_lshrrev_b32 v17, 5, v0
    v_lshl_add_u32 v16, v17, 3, v16
    v_and_b32 v17, 0x70, v3
    v_lshl_add_u32 v16, v16, 13, v17
    s_lshl_b32 s56, s4, 10
    s_lshl_b32 s57, s5, 7
    s_add_u32 s56, s56, s57
    s_add_u32 s52, s22, s56
    s_addc_u32 s53, s23, 0
    s_mov_b32 s54, 3661952
    s_mov_b32 s55, 0x20000
    s_lshl_b32 s14, s11, 10
    s_add_u32 m0, s14, 65536
    s_and_b32 s15, s11, 1
    s_lshl_b32 s15, s15, 17
    s_lshr_b32 s14, s11, 1
    s_lshl_b32 s14, s14, 15
    s_add_u32 s15, s15, s14
    s_movk_i32 s13, 6
L_tl_1:
    buffer_load_dwordx4 v16, s[52:55], s15 offen nt lds
    s_addk_i32 m0, 4096
    s_nop 0
    s_add_u32 s15, s15, 262144
    s_sub_u32 s13, s13, 1
    s_cmp_lg_u32 s13, 0
    s_cbranch_scc1 L_tl_1
    s_barrier
    s_movk_i32 s13, 8
L_tl_2:
    buffer_load_dwordx4 v16, s[52:55], s15 offen nt lds
    s_addk_i32 m0, 4096
    s_nop 0
    s_add_u32 s15, s15, 262144
    s_sub_u32 s13, s13, 1
    s_cmp_lg_u32 s13, 0
    s_cbranch_scc1 L_tl_2
    s_mov_b32 m0, s12
    s_xor_b32 s15, s62, 0
    buffer_load_dwordx4 v1, s[40:43], s15 offen nt lds
    s_addk_i32 m0, 1024
    s_xor_b32 s15, s62, 0
    buffer_load_dwordx4 v2, s[40:43], s15 offen nt lds
    s_addk_i32 m0, 1024
    s_xor_b32 s15, s62, 128
    buffer_load_dwordx4 v1, s[40:43], s15 offen nt lds
    s_addk_i32 m0, 1024
    s_xor_b32 s15, s62, 128
    buffer_load_dwordx4 v2, s[40:43], s15 offen nt lds
    s_branch L_KMAIN
L_SROLE:
    s_setprio 2
    v_mov_b32 v2, 158400
    v_mov_b32 v3, 1
    v_lshlrev_b32 v4, 4, v0
    v_mov_b32 v5, 1073741824
    v_cmp_gt_u32 vcc, 56, v0
    s_mul_i32 s67, s11, 896
    s_mul_i32 s62, s4, 7
    s_add_u32 s62, s62, s5
    s_sub_u32 s62, s62, 22
    v_cndmask_b32 v5, v5, v4, vcc
    v_and_b32 v17, 7, v0
    v_bfe_u32 v18, v0, 4, 2
    v_lshlrev_b32 v18, 1, v18
    v_xor_b32 v17, v17, v18
    v_lshlrev_b32 v17, 4, v17
    v_bfe_u32 v16, v0, 3, 2
    v_lshrrev_b32 v18, 5, v0
    s_waitcnt lgkmcnt(0)
    s_mov_b32 s48, s38
    s_mov_b32 s49, s39
    s_mov_b32 s50, 2359296
    s_mov_b32 s51, 0x20000
    s_mov_b32 s52, s16
    s_mov_b32 s53, s17
    s_mov_b32 s54, 3584
    s_mov_b32 s55, 0x20000
    s_cmp_lg_u32 s66, 0
    s_cbranch_scc1 L_S_NOX
    buffer_load_dwordx4 v[8:11], v5, s[52:55], s67 offen
L_S_NOX:
    s_cmp_eq_u32 s11, 1
    s_cbranch_scc1 L_S1
    s_cmp_eq_u32 s11, 2
    s_cbranch_scc1 L_S2
    s_barrier
    s_cmp_eq_u32 s11, 3
    s_cbranch_scc1 L_S3
    s_cmp_lg_u32 s66, 0
    s_cbranch_scc1 L_S0_TAG
    s_waitcnt vmcnt(0)
    s_call_b64 s[64:65], L_LN1
    s_call_b64 s[64:65], L_QPART
    s_branch L_S0_GATHER
L_S1:
    s_cmp_lg_u32 s66, 2
    s_cbranch_scc1 L_S1_NOWQ
    v_lshlrev_b32 v6, 13, v0
    s_sub_u32 s56, s5, 28
    s_lshl_b32 s56, s56, 20
    s_lshl_b32 s57, s4, 10
    s_add_u32 s57, s57, 384
    s_add_u32 s40, s22, s57
    s_addc_u32 s41, s23, 0
    s_mov_b32 s42, 3661952
    s_mov_b32 s43, 0x20000
    buffer_load_dword v12, v6, s[40:43], s56 offen
    s_add_u32 s56, s56, 524288
    buffer_load_dword v13, v6, s[40:43], s56 offen
L_S1_NOWQ:
    s_barrier
    s_cmp_lg_u32 s66, 0
    s_cbranch_scc1 L_S1_PR
    s_waitcnt vmcnt(0)
    s_call_b64 s[64:65], L_LN1
    s_call_b64 s[64:65], L_QPART
    s_branch L_S1_SM
L_S1_PR:
    s_branch L_NEAR
L_S2:
    v_mov_b32 v19, 0
    buffer_load_dword v7, v19, s[48:51], 0 offen sc1
    v_mov_b32 v12, -1
    v_mov_b32 v13, -1
    v_mov_b32 v14, -1
    v_mov_b32 v15, -1
    v_and_b32 v18, 7, v0
    v_lshlrev_b32 v18, 4, v18
    s_lshl_b32 s56, s4, 15
    s_lshl_b32 s57, s5, 10
    s_add_u32 s56, s56, s57
    s_add_u32 s56, s56, 131072
    buffer_store_dwordx4 v[12:15], v4, s[48:51], s56 offen sc1
    s_barrier
    s_cmp_eq_u32 s66, 2
    s_cbranch_scc0 L_S2_K
    s_lshl_b32 s56, s4, 9
    s_add_u32 s56, s56, 491520
    s_cmp_eq_u32 s5, 31
    s_cselect_b32 s56, s56, 1073741824
    s_mov_b32 exec_hi, 0
    buffer_store_dwordx4 v[12:15], v4, s[48:51], s56 offen sc1
    s_branch L_S2_CLR
L_S2_K:
    s_cmp_eq_u32 s66, 0
    s_cbranch_scc1 L_S2_H
    s_cmp_eq_u32 s66, 1
    s_cbranch_scc1 L_S2_C
    v_lshrrev_b32 v16, 4, v0
    v_lshlrev_b32 v16, 12, v16
    v_and_b32 v17, 15, v0
    v_lshl_add_u32 v16, v17, 4, v16
    s_sub_u32 s57, s5, 8
    s_lshr_b32 s56, s57, 1
    s_lshl_b32 s56, s56, 14
    s_and_b32 s57, s57, 1
    s_lshl_b32 s57, s57, 8
    s_add_u32 s56, s56, s57
    s_lshl_b32 s57, s4, 9
    s_add_u32 s56, s56, s57
    s_add_u32 s56, s56, 524288
    buffer_store_dwordx4 v[12:15], v16, s[48:51], s56 offen sc1
    s_add_u32 s56, s56, 114688
    buffer_store_dwordx4 v[12:15], v16, s[48:51], s56 offen sc1
    s_add_u32 s56, s56, 114688
    buffer_store_dwordx4 v[12:15], v16, s[48:51], s56 offen sc1
    s_add_u32 s56, s56, 114688
    buffer_store_dwordx4 v[12:15], v16, s[48:51], s56 offen sc1
    s_add_u32 s56, s56, 114688
    s_branch L_S2_CLR
L_S2_C:
    v_lshrrev_b32 v17, 3, v0
    v_lshl_add_u32 v16, v17, 13, v18
    s_lshl_b32 s56, s62, 7
    s_add_u32 s56, s56, 1048576
    buffer_store_dwordx4 v[12:15], v16, s[48:51], s56 offen sc1
    s_add_u32 s56, s56, 65536
    buffer_store_dwordx4 v[12:15], v16, s[48:51], s56 offen sc1
    s_add_u32 s56, s56, 65536
    buffer_store_dwordx4 v[12:15], v16, s[48:51], s56 offen sc1
    s_add_u32 s56, s56, 65536
    buffer_store_dwordx4 v[12:15], v16, s[48:51], s56 offen sc1
    s_add_u32 s56, s56, 65536
    buffer_store_dwordx4 v[12:15], v16, s[48:51], s56 offen sc1
    s_add_u32 s56, s56, 65536
    buffer_store_dwordx4 v[12:15], v16, s[48:51], s56 offen sc1
    s_add_u32 s56, s56, 65536
    buffer_store_dwordx4 v[12:15], v16, s[48:51], s56 offen sc1
    s_add_u32 s56, s56, 65536
    buffer_store_dwordx4 v[12:15], v16, s[48:51], s56 offen sc1
    s_add_u32 s56, s56, 65536
    s_branch L_S2_CLR
L_S2_H:
    v_lshrrev_b32 v17, 2, v0
    v_mul_u32_u24 v16, 8192, v17
    v_and_b32 v17, 3, v0
    v_lshl_add_u32 v16, v17, 4, v16
    s_lshl_b32 s56, s2, 7
    s_add_u32 s56, s56, 393216
    s_mov_b32 exec_lo, 0xffff
    s_mov_b32 exec_hi, 0
    buffer_store_dwordx4 v[12:15], v16, s[48:51], s56 offen sc1
L_S2_CLR:
    s_mov_b64 exec, -1
    s_waitcnt vmcnt(2)
    v_readfirstlane_b32 s68, v7
    s_or_b32 s68, s68, 1
    s_mul_i32 s68, s68, 0x9E3779B1
    s_add_u32 s68, s68, 0x85EBCA6A
    s_getreg_b32 s69, hwreg(HW_REG_XCC_ID)
    s_and_b32 s69, s69, 15
    v_mov_b32 v20, s68
    v_mov_b32 v21, s69
    s_mov_b64 exec, 1
    ds_write_b32 v2, v20 offset:0
    s_mov_b64 exec, -1
    s_cmp_lg_u32 s66, 0
    s_cbranch_scc1 L_S2_FLAG
    s_call_b64 s[64:65], L_LN1
    s_branch L_S2_FLAG
L_S3:
    s_cmp_eq_u32 s66, 1
    s_cbranch_scc1 L_FFN
    s_cmp_eq_u32 s66, 3
    s_cbranch_scc0 L_S3_Q
    v_lshl_add_u32 v20, v18, 5, v16
    v_mul_u32_u24 v20, 896, v20
    v_add_u32 v20, v20, v17
    v_add_u32 v21, 3584, v20
    v_add_u32 v22, 14336, v20
    v_add_u32 v23, 17920, v20
    v_add_u32 v24, 7168, v20
    v_add_u32 v25, 10752, v20
    v_add_u32 v26, 21504, v20
    v_add_u32 v27, 25088, v20
    s_sub_u32 s57, s5, 8
    s_and_b32 s56, s57, 1
    s_lshl_b32 s58, s4, 1
    s_add_u32 s56, s56, s58
    s_mul_i32 s56, s56, 229376
    s_lshr_b32 s57, s57, 1
    s_lshl_b32 s57, s57, 7
    s_add_u32 s56, s56, s57
    s_add_u32 s52, s24, s56
    s_addc_u32 s53, s25, 0
    s_mov_b32 s54, 228608
    s_mov_b32 s55, 0x20000
    s_mov_b32 m0, 65536
    s_movk_i32 s15, 0
    s_movk_i32 s13, 4
L_tl_3:
    buffer_load_dwordx4 v20, s[52:55], s15 offen nt lds
    s_addk_i32 m0, 1024
    s_waitcnt vmcnt(5)
    buffer_load_dwordx4 v21, s[52:55], s15 offen nt lds
    s_addk_i32 m0, 1024
    s_waitcnt vmcnt(5)
    buffer_load_dwordx4 v22, s[52:55], s15 offen nt lds
    s_addk_i32 m0, 1024
    s_waitcnt vmcnt(5)
    buffer_load_dwordx4 v23, s[52:55], s15 offen nt lds
    s_addk_i32 m0, 1024
    s_waitcnt vmcnt(5)
    buffer_load_dwordx4 v24, s[52:55], s15 offen nt lds
    s_addk_i32 m0, 1024
    s_waitcnt vmcnt(5)
    buffer_load_dwordx4 v25, s[52:55], s15 offen nt lds
    s_addk_i32 m0, 1024
    s_waitcnt vmcnt(5)
    buffer_load_dwordx4 v26, s[52:55], s15 offen nt lds
    s_addk_i32 m0, 1024
    s_waitcnt vmcnt(5)
    buffer_load_dwordx4 v27, s[52:55], s15 offen nt lds
    s_addk_i32 m0, 1024
    s_waitcnt vmcnt(5)
    s_add_u32 s15, s15, 57344
    s_sub_u32 s13, s13, 1
    s_cmp_lg_u32 s13, 0
    s_cbranch_scc1 L_tl_3
    s_waitcnt vmcnt(0)
    s_mov_b64 exec, 1
    ds_add_u32 v2, v3 offset:32
    s_mov_b64 exec, -1
    s_branch L_STAGE2
L_S3_Q:
    s_cmp_lg_u32 s66, 0
    s_cbranch_scc1 L_S3_PF
    s_waitcnt vmcnt(0)
    s_call_b64 s[64:65], L_LN1
    s_call_b64 s[64:65], L_QPART
    s_branch L_S3_PF
L_NEAR:
    s_load_dword s40, s[38:39], 0x400
    s_and_b32 s63, s5, 1
    s_lshr_b32 s56, s5, 2
    s_lshl_b32 s57, s63, 3
    s_or_b32 s56, s56, s57
    s_lshr_b32 s57, s4, 2
    s_lshl_b32 s57, s57, 4
    s_or_b32 s56, s56, s57
    s_lshl_b32 s56, s56, 14
    s_lshl_b32 s57, s63, 13
    s_or_b32 s56, s56, s57
    s_and_b32 s57, s5, 2
    s_lshl_b32 s57, s57, 11
    s_or_b32 s56, s56, s57
    s_add_u32 s57, s4, s6
    s_and_b32 s57, s57, 3
    s_lshl_b32 s57, s57, 8
    s_or_b32 s56, s56, s57
    s_add_u32 s56, s56, 1572864
    s_xor_b32 s54, s56, 8192
    s_add_u32 s56, s38, s56
    s_addc_u32 s57, s39, 0
    s_add_u32 s54, s38, s54
    s_addc_u32 s55, s39, 0
    s_waitcnt lgkmcnt(0)
    s_memtime s[42:43]
    s_waitcnt lgkmcnt(0)
    s_load_dword s40, s[56:57], 0
    s_load_dword s41, s[56:57], 2048
    s_waitcnt lgkmcnt(0)
    s_memtime s[44:45]
    s_waitcnt lgkmcnt(0)
    s_load_dword s40, s[54:55], 0
    s_load_dword s41, s[54:55], 2048
    s_waitcnt lgkmcnt(0)
    s_memtime s[46:47]
    s_waitcnt lgkmcnt(0)
    s_load_dword s40, s[54:55], 1024
    s_load_dword s41, s[54:55], 3072
    s_waitcnt lgkmcnt(0)
    s_memtime s[60:61]
    s_waitcnt lgkmcnt(0)
    s_load_dword s40, s[56:57], 1024
    s_load_dword s41, s[56:57], 3072
    s_waitcnt lgkmcnt(0)
    s_memtime s[58:59]
    s_waitcnt lgkmcnt(0)
    s_sub_u32 s40, s58, s42
    s_sub_u32 s41, s60, s44
    s_lshl_b32 s41, s41, 1
    s_sub_i32 s40, s40, s41
    s_sub_i32 s41, 0, s40
    s_cmp_eq_u32 s63, 0
    s_cselect_b32 s40, s40, s41
    s_min_i32 s40, s40, 600
    s_max_i32 s40, s40, -600
    s_lshl_b32 s56, s4, 8
    s_lshl_b32 s57, s5, 3
    s_add_u32 s56, s56, s57
    v_mov_b32 v29, s40
    v_mov_b32 v30, 0
L_wf_4:
    ds_read_b32 v28, v2 offset:0
    s_waitcnt lgkmcnt(0)
    v_readfirstlane_b32 s14, v28
    s_cmp_ge_u32 s14, 1
    s_cbranch_scc0 L_wf_4
    s_mov_b64 exec, 1
    buffer_store_dwordx2 v[28:29], v30, s[48:51], s56 offen offset:2048
    ds_add_u32 v2, v3 offset:40
    s_mov_b64 exec, -1
    s_branch L_S1_SM
L_LN1:
    v_lshlrev_b32 v24, 16, v8
    v_and_b32 v25, 0xffff0000, v8
    v_lshlrev_b32 v26, 16, v9
    v_and_b32 v27, 0xffff0000, v9
    v_lshlrev_b32 v28, 16, v10
    v_and_b32 v29, 0xffff0000, v10
    v_lshlrev_b32 v30, 16, v11
    v_and_b32 v31, 0xffff0000, v11
    v_readfirstlane_b32 s56, v24
    v_mov_b32 v40, 0
    v_mov_b32 v41, 0
    s_mov_b32 exec_hi, 0x00ffffff
    v_pk_add_f32 v[32:33], v[24:25], s[56:57] op_sel_hi:[1,0] neg_lo:[0,1] neg_hi:[0,1]
    v_pk_add_f32 v[34:35], v[26:27], s[56:57] op_sel_hi:[1,0] neg_lo:[0,1] neg_hi:[0,1]
    v_pk_add_f32 v[36:37], v[28:29], s[56:57] op_sel_hi:[1,0] neg_lo:[0,1] neg_hi:[0,1]
    v_pk_add_f32 v[38:39], v[30:31], s[56:57] op_sel_hi:[1,0] neg_lo:[0,1] neg_hi:[0,1]
    v_pk_mul_f32 v[42:43], v[32:33], v[32:33]
    v_pk_fma_f32 v[42:43], v[34:35], v[34:35], v[42:43]
    v_pk_fma_f32 v[42:43], v[36:37], v[36:37], v[42:43]
    v_pk_fma_f32 v[42:43], v[38:39], v[38:39], v[42:43]
    v_pk_add_f32 v[32:33], v[32:33], v[34:35]
    v_pk_add_f32 v[36:37], v[36:37], v[38:39]
    v_pk_add_f32 v[32:33], v[32:33], v[36:37]
    v_add_f32 v41, v42, v43
    v_add_f32 v40, v32, v33
    s_mov_b64 exec, -1
    s_nop 0
    s_nop 0
    v_add_f32_dpp v41, v41, v41 row_shr:1 row_mask:0xf bank_mask:0xf
    v_add_f32_dpp v40, v40, v40 row_shr:1 row_mask:0xf bank_mask:0xf
    s_nop 0
    v_add_f32_dpp v41, v41, v41 row_shr:2 row_mask:0xf bank_mask:0xf
    v_add_f32_dpp v40, v40, v40 row_shr:2 row_mask:0xf bank_mask:0xf
    s_nop 0
    v_add_f32_dpp v41, v41, v41 row_shr:4 row_mask:0xf bank_mask:0xf
    v_add_f32_dpp v40, v40, v40 row_shr:4 row_mask:0xf bank_mask:0xf
    s_nop 0
    v_add_f32_dpp v41, v41, v41 row_shr:8 row_mask:0xf bank_mask:0xf
    v_add_f32_dpp v40, v40, v40 row_shr:8 row_mask:0xf bank_mask:0xf
    s_nop 0
    v_add_f32_dpp v41, v41, v41 row_bcast:15 row_mask:0xa bank_mask:0xf
    v_add_f32_dpp v40, v40, v40 row_bcast:15 row_mask:0xa bank_mask:0xf
    s_nop 0
    v_add_f32_dpp v41, v41, v41 row_bcast:31 row_mask:0xc bank_mask:0xf
    v_add_f32_dpp v40, v40, v40 row_bcast:31 row_mask:0xc bank_mask:0xf
    s_nop 0
    v_readlane_b32 s58, v41, 63
    v_readlane_b32 s57, v40, 63
    v_mov_b32 v34, 0x3b124925
    v_mul_f32 v33, s58, v34
    v_mul_f32 v32, s57, v34
    v_fma_f32 v33, -v32, v32, v33
    v_add_f32 v32, s56, v32
    v_max_f32 v33, 0, v33
    v_cvt_pk_bf16_f32 v34, v32, v33
    v_and_b32 v33, 0xffff0000, v34
    v_lshlrev_b32 v32, 16, v34
    v_add_f32 v33, 0x3727c5ac, v33
    v_cvt_pk_bf16_f32 v33, v33, v33
    v_lshlrev_b32 v33, 16, v33
    v_sqrt_f32 v33, v33
    v_pk_add_f32 v[24:25], v[24:25], v[32:33] op_sel_hi:[1,0] neg_lo:[0,1] neg_hi:[0,1]
    v_pk_add_f32 v[26:27], v[26:27], v[32:33] op_sel_hi:[1,0] neg_lo:[0,1] neg_hi:[0,1]
    v_pk_add_f32 v[28:29], v[28:29], v[32:33] op_sel_hi:[1,0] neg_lo:[0,1] neg_hi:[0,1]
    v_pk_add_f32 v[30:31], v[30:31], v[32:33] op_sel_hi:[1,0] neg_lo:[0,1] neg_hi:[0,1]
    v_cvt_pk_bf16_f32 v34, v33, v33
    v_lshlrev_b32 v34, 16, v34
    v_rcp_f32 v34, v34
    v_cvt_pk_bf16_f32 v8, v24, v25
    v_cvt_pk_bf16_f32 v9, v26, v27
    v_cvt_pk_bf16_f32 v10, v28, v29
    v_cvt_pk_bf16_f32 v11, v30, v31
    v_lshlrev_b32 v24, 16, v8
    v_and_b32 v25, 0xffff0000, v8
    v_lshlrev_b32 v26, 16, v9
    v_and_b32 v27, 0xffff0000, v9
    v_lshlrev_b32 v28, 16, v10
    v_and_b32 v29, 0xffff0000, v10
    v_lshlrev_b32 v30, 16, v11
    v_and_b32 v31, 0xffff0000, v11
    v_pk_mul_f32 v[24:25], v[24:25], v[34:35] op_sel_hi:[1,0]
    v_pk_mul_f32 v[26:27], v[26:27], v[34:35] op_sel_hi:[1,0]
    v_pk_mul_f32 v[28:29], v[28:29], v[34:35] op_sel_hi:[1,0]
    v_pk_mul_f32 v[30:31], v[30:31], v[34:35] op_sel_hi:[1,0]
    v_cvt_pk_bf16_f32 v8, v24, v25
    v_cvt_pk_bf16_f32 v9, v26, v27
    v_cvt_pk_bf16_f32 v10, v28, v29
    v_cvt_pk_bf16_f32 v11, v30, v31
    s_mul_i32 s14, s11, 960
    s_add_u32 s14, s14, 151552
    v_add_u32 v6, s14, v4
    s_mov_b32 exec_hi, 0x00ffffff
    ds_write_b128 v6, v[8:11]
    s_mov_b64 exec, 1
    ds_add_u32 v2, v3 offset:4
    s_mov_b64 exec, -1
    s_setpc_b64 s[64:65]
L_QPART:
    v_lshrrev_b32 v24, 2, v0
    v_bfe_u32 v25, v0, 3, 2
    v_and_b32 v26, 3, v0
    v_lshlrev_b32 v24, 7, v24
    v_lshl_add_u32 v24, v26, 3, v24
    v_xor_b32 v25, s11, v25
    v_lshl_add_u32 v24, v25, 5, v24
    v_add_u32 v24, 65536, v24
    v_lshrrev_b32 v25, 4, v0
    v_mul_u32_u24 v6, 960, v26
    v_lshl_add_u32 v6, v25, 4, v6
    v_add_u32 v6, 151552, v6
    v_lshlrev_b32 v27, 14, v26
    v_lshl_add_u32 v27, v25, 4, v27
    s_lshl_b32 s56, s4, 11
    s_lshl_b32 s57, s5, 8
    s_add_u32 s56, s56, s57
    s_lshl_b32 s57, s11, 6
    s_add_u32 s56, s56, s57
    s_add_u32 s56, s56, 8192
    s_add_u32 s57, s56, 974848
L_wf_5:
    ds_read_b32 v28, v2 offset:4
    s_waitcnt lgkmcnt(0)
    v_readfirstlane_b32 s14, v28
    s_cmp_ge_u32 s14, 4
    s_cbranch_scc0 L_wf_5
    ds_read_b128 v[48:51], v6 offset:0
    ds_read_b128 v[52:55], v6 offset:64
    ds_read_b128 v[56:59], v6 offset:128
    ds_read_b128 v[60:63], v6 offset:192
    ds_read_b128 v[64:67], v6 offset:256
    ds_read_b128 v[68:71], v6 offset:320
    ds_read_b128 v[72:75], v6 offset:384
    ds_read_b128 v[76:79], v6 offset:448
    ds_read_b128 v[80:83], v6 offset:512
    ds_read_b128 v[84:87], v6 offset:576
    ds_read_b128 v[88:91], v6 offset:640
    ds_read_b128 v[92:95], v6 offset:704
    ds_read_b128 v[96:99], v6 offset:768
    ds_read_b128 v[100:103], v6 offset:832
L_wf_6:
    ds_read_b32 v28, v2 offset:0
    s_waitcnt lgkmcnt(0)
    v_readfirstlane_b32 s14, v28
    s_cmp_ge_u32 s14, 1
    s_cbranch_scc0 L_wf_6
    v_mov_b32 v9, s14
    v_mov_b32 v11, s14
L_wf_7:
    ds_read_b32 v28, v2 offset:36
    s_waitcnt lgkmcnt(0)
    v_readfirstlane_b32 s14, v28
    s_cmp_ge_u32 s14, 4
    s_cbranch_scc0 L_wf_7
    ds_read_b64_tr_b16 v[104:105], v24 offset:0
    ds_read_b64_tr_b16 v[106:107], v24 offset:2048
    ds_read_b64_tr_b16 v[108:109], v24 offset:4096
    ds_read_b64_tr_b16 v[110:111], v24 offset:6144
    ds_read_b64_tr_b16 v[112:113], v24 offset:8192
    ds_read_b64_tr_b16 v[114:115], v24 offset:10240
    ds_read_b64_tr_b16 v[116:117], v24 offset:12288
    ds_read_b64_tr_b16 v[118:119], v24 offset:14336
    ds_read_b64_tr_b16 v[120:121], v24 offset:16384
    ds_read_b64_tr_b16 v[122:123], v24 offset:18432
    ds_read_b64_tr_b16 v[124:125], v24 offset:20480
    ds_read_b64_tr_b16 v[126:127], v24 offset:22528
    ds_read_b64_tr_b16 v[128:129], v24 offset:24576
    ds_read_b64_tr_b16 v[130:131], v24 offset:26624
    s_waitcnt lgkmcnt(12)
    v_mfma_f32_16x16x32_bf16 v[160:163], v[104:107], v[48:51], 0
    ds_read_b64_tr_b16 v[132:133], v24 offset:28672
    ds_read_b64_tr_b16 v[134:135], v24 offset:30720
    s_waitcnt lgkmcnt(12)
    v_mfma_f32_16x16x32_bf16 v[160:163], v[108:111], v[52:55], v[160:163]
    ds_read_b64_tr_b16 v[136:137], v24 offset:32768
    ds_read_b64_tr_b16 v[138:139], v24 offset:34816
    s_waitcnt lgkmcnt(12)
    v_mfma_f32_16x16x32_bf16 v[160:163], v[112:115], v[56:59], v[160:163]
    ds_read_b64_tr_b16 v[140:141], v24 offset:36864
    ds_read_b64_tr_b16 v[142:143], v24 offset:38912
    s_waitcnt lgkmcnt(12)
    v_mfma_f32_16x16x32_bf16 v[160:163], v[116:119], v[60:63], v[160:163]
    ds_read_b64_tr_b16 v[144:145], v24 offset:40960
    ds_read_b64_tr_b16 v[146:147], v24 offset:43008
    s_waitcnt lgkmcnt(12)
    v_mfma_f32_16x16x32_bf16 v[160:163], v[120:123], v[64:67], v[160:163]
    ds_read_b64_tr_b16 v[148:149], v24 offset:45056
    ds_read_b64_tr_b16 v[150:151], v24 offset:47104
    s_waitcnt lgkmcnt(12)
    v_mfma_f32_16x16x32_bf16 v[160:163], v[124:127], v[68:71], v[160:163]
    ds_read_b64_tr_b16 v[152:153], v24 offset:49152
    ds_read_b64_tr_b16 v[154:155], v24 offset:51200
    s_waitcnt lgkmcnt(12)
    v_mfma_f32_16x16x32_bf16 v[160:163], v[128:131], v[72:75], v[160:163]
    ds_read_b64_tr_b16 v[156:157], v24 offset:53248
    ds_read_b64_tr_b16 v[158:159], v24 offset:55296
    s_waitcnt lgkmcnt(12)
    v_mfma_f32_16x16x32_bf16 v[160:163], v[132:135], v[76:79], v[160:163]
    s_waitcnt lgkmcnt(10)
    v_mfma_f32_16x16x32_bf16 v[160:163], v[136:139], v[80:83], v[160:163]
    s_waitcnt lgkmcnt(8)
    v_mfma_f32_16x16x32_bf16 v[160:163], v[140:143], v[84:87], v[160:163]
    s_waitcnt lgkmcnt(6)
    v_mfma_f32_16x16x32_bf16 v[160:163], v[144:147], v[88:91], v[160:163]
    s_waitcnt lgkmcnt(4)
    v_mfma_f32_16x16x32_bf16 v[160:163], v[148:151], v[92:95], v[160:163]
    s_waitcnt lgkmcnt(2)
    v_mfma_f32_16x16x32_bf16 v[160:163], v[152:155], v[96:99], v[160:163]
    s_waitcnt lgkmcnt(0)
    v_mfma_f32_16x16x32_bf16 v[160:163], v[156:159], v[100:103], v[160:163]
    s_mov_b32 exec_lo, 0x000f000f
    s_mov_b32 exec_hi, 0x000f000f
    s_nop 5
    v_cvt_pk_bf16_f32 v8, v160, v161
    v_cvt_pk_bf16_f32 v10, v162, v163
    buffer_store_dwordx4 v[8:11], v27, s[48:51], s57 offen
    buffer_store_dwordx4 v[8:11], v27, s[48:51], s56 offen sc1
    s_mov_b64 exec, -1
    s_setpc_b64 s[64:65]
L_KMAIN:
    s_add_u32 s44, s20, s58
    s_addc_u32 s45, s21, 0
    s_mov_b32 s46, 65152
    s_mov_b32 s47, 0x20000
    s_mov_b32 s48, s38
    s_mov_b32 s49, s39
    s_mov_b32 s50, 2359296
    s_mov_b32 s51, 0x20000
    v_and_b32 v189, 15, v0
    v_lshrrev_b32 v14, 4, v0
    v_lshrrev_b32 v15, 1, v189
    v_xor_b32 v4, v14, v15
    v_lshlrev_b32 v4, 4, v4
    v_lshl_add_u32 v4, v189, 7, v4
    v_add_u32 v4, s12, v4
    v_xor_b32 v5, 64, v4
    v_and_b32 v15, 1, v0
    v_mul_u32_u24 v10, 576, v15
    v_lshl_add_u32 v10, v14, 4, v10
    v_add_u32 v10, 155392, v10
    v_mul_u32_u24 v11, 320, v15
    v_lshl_add_u32 v11, v14, 4, v11
    s_lshl_b32 s14, s11, 6
    s_add_u32 s14, s14, 156544
    v_add_u32 v12, s14, v11
    v_add_u32 v11, 157184, v11
    v_mov_b32 v184, 158144
    v_and_b32 v185, 2, v0
    v_cmp_eq_u32 vcc, 0, v185
    v_lshlrev_b32 v188, 13, v15
    v_lshl_add_u32 v188, v14, 9, v188
    v_cndmask_b32 v186, v184, v11, vcc
    v_cndmask_b32 v187, v11, v184, vcc
    v_lshl_add_u32 v188, v185, 7, v188
    v_mov_b32 v184, 1073741824
    v_cmp_gt_u32 vcc, 4, v189
    s_lshr_b32 s59, s8, 1
    s_lshl_b32 s59, s59, 14
    v_cndmask_b32 v188, v184, v188, vcc
    s_lshl_b32 s14, s11, 11
    s_add_u32 s59, s59, s14
    s_and_b32 s14, s5, 15
    s_lshl_b32 s14, s14, 4
    s_add_u32 s59, s59, s14
    s_add_u32 s59, s59, 131072
    v_lshrrev_b32 v189, 2, v0
    v_bfe_u32 v14, v0, 3, 2
    v_and_b32 v15, 3, v0
    v_lshlrev_b32 v189, 7, v189
    v_lshl_add_u32 v189, v15, 3, v189
    v_add_u32 v189, s12, v189
    v_xor_b32 v15, 0, v14
    v_lshl_add_u32 v6, v15, 5, v189
    v_xor_b32 v15, 1, v14
    v_lshl_add_u32 v7, v15, 5, v189
    v_xor_b32 v15, 2, v14
    v_lshl_add_u32 v8, v15, 5, v189
    v_xor_b32 v15, 3, v14
    v_lshl_add_u32 v9, v15, 5, v189
    v_mov_b32 v14, 1
    s_mov_b32 s60, 0
    s_cmp_lg_u32 s66, 0
    s_cselect_b64 vcc, -1, 0
    s_cbranch_vccz L_thr_8
    s_waitcnt vmcnt(3)
L_thr_8:
    s_addk_i32 m0, 1024
    s_xor_b32 s15, s62, 256
    buffer_load_dwordx4 v1, s[40:43], s15 offen nt lds
    s_cbranch_vccz L_thr_9
    s_waitcnt vmcnt(3)
L_thr_9:
    s_addk_i32 m0, 1024
    s_xor_b32 s15, s62, 256
    buffer_load_dwordx4 v2, s[40:43], s15 offen nt lds
    s_cbranch_vccz L_thr_10
    s_waitcnt vmcnt(3)
L_thr_10:
    s_addk_i32 m0, 1024
    s_xor_b32 s15, s62, 384
    buffer_load_dwordx4 v1, s[40:43], s15 offen nt lds
    s_cbranch_vccz L_thr_11
    s_waitcnt vmcnt(3)
L_thr_11:
    s_addk_i32 m0, 1024
    s_xor_b32 s15, s62, 384
    buffer_load_dwordx4 v2, s[40:43], s15 offen nt lds
    s_waitcnt vmcnt(8)
    s_mov_b64 exec, 1
    ds_add_u32 v13, v14 offset:36
    s_mov_b64 exec, -1
    s_waitcnt vmcnt(7) lgkmcnt(0)
    s_cbranch_vccz L_thr_12
    s_waitcnt vmcnt(3)
L_thr_12:
    s_addk_i32 m0, 1024
    s_xor_b32 s15, s62, 8192
    buffer_load_dwordx4 v1, s[40:43], s15 offen nt lds
    s_waitcnt vmcnt(7) lgkmcnt(0)
    ds_read_b128 v[16:19], v4 offset:0
    ds_read_b128 v[20:23], v5 offset:0
    s_cbranch_vccz L_thr_13
    s_waitcnt vmcnt(3)
L_thr_13:
    s_addk_i32 m0, 1024
    s_xor_b32 s15, s62, 8192
    buffer_load_dwordx4 v2, s[40:43], s15 offen nt lds
    s_waitcnt vmcnt(7) lgkmcnt(0)
    s_cbranch_vccz L_thr_14
    s_waitcnt vmcnt(3)
L_thr_14:
    s_addk_i32 m0, 1024
    s_xor_b32 s15, s62, 8320
    buffer_load_dwordx4 v1, s[40:43], s15 offen nt lds
    s_waitcnt vmcnt(7) lgkmcnt(0)
    ds_read_b128 v[24:27], v4 offset:2048
    ds_read_b128 v[28:31], v5 offset:2048
    s_cbranch_vccz L_thr_15
    s_waitcnt vmcnt(3)
L_thr_15:
    s_addk_i32 m0, 1024
    s_xor_b32 s15, s62, 8320
    buffer_load_dwordx4 v2, s[40:43], s15 offen nt lds
    s_waitcnt vmcnt(7) lgkmcnt(0)
    s_cbranch_vccz L_thr_16
    s_waitcnt vmcnt(3)
L_thr_16:
    s_addk_i32 m0, 1024
    s_xor_b32 s15, s62, 8448
    buffer_load_dwordx4 v1, s[40:43], s15 offen nt lds
    s_waitcnt vmcnt(7) lgkmcnt(0)
    ds_read_b128 v[32:35], v4 offset:4096
    ds_read_b128 v[36:39], v5 offset:4096
    s_mov_b64 exec, 1
    ds_add_u32 v13, v14 offset:24
    s_mov_b64 exec, -1
    s_cbranch_vccz L_thr_17
    s_waitcnt vmcnt(3)
L_thr_17:
    s_addk_i32 m0, 1024
    s_xor_b32 s15, s62, 8448
    buffer_load_dwordx4 v2, s[40:43], s15 offen nt lds
    s_waitcnt vmcnt(7) lgkmcnt(0)
    s_cbranch_vccz L_thr_18
    s_waitcnt vmcnt(3)
L_thr_18:
    s_addk_i32 m0, 1024
    s_xor_b32 s15, s62, 8576
    buffer_load_dwordx4 v1, s[40:43], s15 offen nt lds
    s_waitcnt vmcnt(7) lgkmcnt(0)
    ds_read_b128 v[40:43], v4 offset:6144
    ds_read_b128 v[44:47], v5 offset:6144
    s_cbranch_vccz L_thr_19
    s_waitcnt vmcnt(3)
L_thr_19:
    s_addk_i32 m0, 1024
    s_xor_b32 s15, s62, 8576
    buffer_load_dwordx4 v2, s[40:43], s15 offen nt lds
    s_waitcnt vmcnt(7) lgkmcnt(0)
    s_cbranch_vccz L_thr_20
    s_waitcnt vmcnt(3)
L_thr_20:
    s_mov_b32 m0, s12
    s_xor_b32 s15, s63, 0
    buffer_load_dwordx4 v3, s[44:47], s15 offen nt lds
    s_waitcnt vmcnt(7) lgkmcnt(0)
    ds_read_b128 v[48:51], v4 offset:8192
    ds_read_b128 v[52:55], v5 offset:8192
    s_cbranch_vccz L_thr_21
    s_waitcnt vmcnt(3)
L_thr_21:
    s_addk_i32 m0, 1024
    s_xor_b32 s15, s63, 4096
    buffer_load_dwordx4 v3, s[44:47], s15 offen nt lds
    s_waitcnt vmcnt(7) lgkmcnt(0)
    s_cbranch_vccz L_thr_22
    s_waitcnt vmcnt(3)
L_thr_22:
    s_addk_i32 m0, 1024
    s_xor_b32 s15, s63, 8192
    buffer_load_dwordx4 v3, s[44:47], s15 offen nt lds
    s_waitcnt vmcnt(7) lgkmcnt(0)
    ds_read_b128 v[56:59], v4 offset:10240
    ds_read_b128 v[60:63], v5 offset:10240
    s_cbranch_vccz L_thr_23
    s_waitcnt vmcnt(3)
L_thr_23:
    s_addk_i32 m0, 1024
    s_xor_b32 s15, s63, 12288
    buffer_load_dwordx4 v3, s[44:47], s15 offen nt lds
    s_waitcnt vmcnt(7) lgkmcnt(0)
    s_cbranch_vccz L_thr_24
    s_waitcnt vmcnt(6)
L_thr_24:
    s_addk_i32 m0, 1024
    s_xor_b32 s15, s63, 16384
    buffer_load_dwordx4 v3, s[44:47], s15 offen nt lds
    s_waitcnt vmcnt(7) lgkmcnt(0)
    ds_read_b128 v[64:67], v4 offset:12288
    ds_read_b128 v[68:71], v5 offset:12288
    s_cbranch_vccz L_thr_25
    s_waitcnt vmcnt(6)
L_thr_25:
    s_addk_i32 m0, 1024
    s_xor_b32 s15, s63, 20480
    buffer_load_dwordx4 v3, s[44:47], s15 offen nt lds
    s_waitcnt vmcnt(7) lgkmcnt(0)
    s_cbranch_vccz L_thr_26
    s_waitcnt vmcnt(6)
L_thr_26:
    s_addk_i32 m0, 1024
    s_xor_b32 s15, s63, 24576
    buffer_load_dwordx4 v3, s[44:47], s15 offen nt lds
    s_waitcnt vmcnt(7) lgkmcnt(0)
    ds_read_b128 v[72:75], v4 offset:14336
    ds_read_b128 v[76:79], v5 offset:14336
    s_cmp_lg_u32 s60, 0
    s_cbranch_scc1 L_kchk_27
    ds_read_b32 v15, v13 offset:8
    s_waitcnt lgkmcnt(0)
    v_readfirstlane_b32 s14, v15
    s_cmp_eq_u32 s14, 0
    s_cbranch_scc1 L_kchk_27
    s_call_b64 s[64:65], L_SCORES
L_kchk_27:
    s_cbranch_vccz L_thr_28
    s_waitcnt vmcnt(6)
L_thr_28:
    s_addk_i32 m0, 1024
    s_xor_b32 s15, s63, 28672
    buffer_load_dwordx4 v3, s[44:47], s15 offen nt lds
    s_waitcnt vmcnt(7) lgkmcnt(0)
    s_cmp_lg_u32 s60, 0
    s_cbranch_scc1 L_kchk_29
    ds_read_b32 v15, v13 offset:8
    s_waitcnt lgkmcnt(0)
    v_readfirstlane_b32 s14, v15
    s_cmp_eq_u32 s14, 0
    s_cbranch_scc1 L_kchk_29
    s_call_b64 s[64:65], L_SCORES
L_kchk_29:
    s_cbranch_vccz L_thr_30
    s_waitcnt vmcnt(6)
L_thr_30:
    s_addk_i32 m0, 1024
    s_xor_b32 s15, s63, 32768
    buffer_load_dwordx4 v3, s[44:47], s15 offen nt lds
    s_waitcnt vmcnt(7) lgkmcnt(0)
    s_cmp_lg_u32 s60, 0
    s_cbranch_scc1 L_kchk_31
    ds_read_b32 v15, v13 offset:8
    s_waitcnt lgkmcnt(0)
    v_readfirstlane_b32 s14, v15
    s_cmp_eq_u32 s14, 0
    s_cbranch_scc1 L_kchk_31
    s_call_b64 s[64:65], L_SCORES
L_kchk_31:
    s_cbranch_vccz L_thr_32
    s_waitcnt vmcnt(6)
L_thr_32:
    s_addk_i32 m0, 1024
    s_xor_b32 s15, s63, 36864
    buffer_load_dwordx4 v3, s[44:47], s15 offen nt lds
    s_waitcnt vmcnt(7) lgkmcnt(0)
    s_cmp_lg_u32 s60, 0
    s_cbranch_scc1 L_kchk_33
    ds_read_b32 v15, v13 offset:8
    s_waitcnt lgkmcnt(0)
    v_readfirstlane_b32 s14, v15
    s_cmp_eq_u32 s14, 0
    s_cbranch_scc1 L_kchk_33
    s_call_b64 s[64:65], L_SCORES
L_kchk_33:
    s_cbranch_vccz L_thr_34
    s_waitcnt vmcnt(6)
L_thr_34:
    s_addk_i32 m0, 1024
    s_xor_b32 s15, s63, 40960
    buffer_load_dwordx4 v3, s[44:47], s15 offen nt lds
    s_waitcnt vmcnt(7) lgkmcnt(0)
    ds_read_b64_tr_b16 v[80:81], v6 offset:0
    ds_read_b64_tr_b16 v[82:83], v6 offset:2048
    ds_read_b64_tr_b16 v[84:85], v7 offset:0
    ds_read_b64_tr_b16 v[86:87], v7 offset:2048
    ds_read_b64_tr_b16 v[88:89], v8 offset:0
    ds_read_b64_tr_b16 v[90:91], v8 offset:2048
    ds_read_b64_tr_b16 v[92:93], v9 offset:0
    ds_read_b64_tr_b16 v[94:95], v9 offset:2048
    s_cmp_lg_u32 s60, 0
    s_cbranch_scc1 L_kchk_35
    ds_read_b32 v15, v13 offset:8
    s_waitcnt lgkmcnt(0)
    v_readfirstlane_b32 s14, v15
    s_cmp_eq_u32 s14, 0
    s_cbranch_scc1 L_kchk_35
    s_call_b64 s[64:65], L_SCORES
L_kchk_35:
    s_cbranch_vccz L_thr_36
    s_waitcnt vmcnt(6)
L_thr_36:
    s_addk_i32 m0, 1024
    s_xor_b32 s15, s63, 45056
    buffer_load_dwordx4 v3, s[44:47], s15 offen nt lds
    s_waitcnt vmcnt(7) lgkmcnt(0)
    s_cmp_lg_u32 s60, 0
    s_cbranch_scc1 L_kchk_37
    ds_read_b32 v15, v13 offset:8
    s_waitcnt lgkmcnt(0)
    v_readfirstlane_b32 s14, v15
    s_cmp_eq_u32 s14, 0
    s_cbranch_scc1 L_kchk_37
    s_call_b64 s[64:65], L_SCORES
L_kchk_37:
    s_cbranch_vccz L_thr_38
    s_waitcnt vmcnt(6)
L_thr_38:
    s_addk_i32 m0, 1024
    s_xor_b32 s15, s63, 49152
    buffer_load_dwordx4 v3, s[44:47], s15 offen nt lds
    s_waitcnt vmcnt(7) lgkmcnt(0)
    s_cmp_lg_u32 s60, 0
    s_cbranch_scc1 L_kchk_39
    ds_read_b32 v15, v13 offset:8
    s_waitcnt lgkmcnt(0)
    v_readfirstlane_b32 s14, v15
    s_cmp_eq_u32 s14, 0
    s_cbranch_scc1 L_kchk_39
    s_call_b64 s[64:65], L_SCORES
L_kchk_39:
    s_cbranch_vccz L_thr_40
    s_waitcnt vmcnt(6)
L_thr_40:
    s_addk_i32 m0, 1024
    s_xor_b32 s15, s63, 53248
    buffer_load_dwordx4 v3, s[44:47], s15 offen nt lds
    s_waitcnt vmcnt(7) lgkmcnt(0)
    s_cmp_lg_u32 s60, 0
    s_cbranch_scc1 L_kchk_41
    ds_read_b32 v15, v13 offset:8
    s_waitcnt lgkmcnt(0)
    v_readfirstlane_b32 s14, v15
    s_cmp_eq_u32 s14, 0
    s_cbranch_scc1 L_kchk_41
    s_call_b64 s[64:65], L_SCORES
L_kchk_41:
    s_cbranch_vccz L_thr_42
    s_waitcnt vmcnt(6)
L_thr_42:
    s_addk_i32 m0, 1024
    s_xor_b32 s15, s63, 57344
    buffer_load_dwordx4 v3, s[44:47], s15 offen nt lds
    s_waitcnt vmcnt(7) lgkmcnt(0)
    ds_read_b64_tr_b16 v[96:97], v6 offset:4096
    ds_read_b64_tr_b16 v[98:99], v6 offset:6144
    ds_read_b64_tr_b16 v[100:101], v7 offset:4096
    ds_read_b64_tr_b16 v[102:103], v7 offset:6144
    ds_read_b64_tr_b16 v[104:105], v8 offset:4096
    ds_read_b64_tr_b16 v[106:107], v8 offset:6144
    ds_read_b64_tr_b16 v[108:109], v9 offset:4096
    ds_read_b64_tr_b16 v[110:111], v9 offset:6144
    s_cmp_lg_u32 s60, 0
    s_cbranch_scc1 L_kchk_43
    ds_read_b32 v15, v13 offset:8
    s_waitcnt lgkmcnt(0)
    v_readfirstlane_b32 s14, v15
    s_cmp_eq_u32 s14, 0
    s_cbranch_scc1 L_kchk_43
    s_call_b64 s[64:65], L_SCORES
L_kchk_43:
    s_cbranch_vccz L_thr_44
    s_waitcnt vmcnt(6)
L_thr_44:
    s_addk_i32 m0, 1024
    s_xor_b32 s15, s63, 61440
    buffer_load_dwordx4 v3, s[44:47], s15 offen nt lds
    s_cmp_lg_u32 s60, 0
    s_cbranch_scc1 L_kchk_45
L_wf_46:
    ds_read_b32 v15, v13 offset:8
    s_waitcnt lgkmcnt(0)
    v_readfirstlane_b32 s14, v15
    s_cmp_ge_u32 s14, 1
    s_cbranch_scc0 L_wf_46
    s_call_b64 s[64:65], L_SCORES
L_kchk_45:
    s_waitcnt vmcnt(4) lgkmcnt(0)
    ds_read_b64_tr_b16 v[112:113], v6 offset:8192
    ds_read_b64_tr_b16 v[114:115], v6 offset:10240
    ds_read_b64_tr_b16 v[116:117], v7 offset:8192
    ds_read_b64_tr_b16 v[118:119], v7 offset:10240
    ds_read_b64_tr_b16 v[120:121], v8 offset:8192
    ds_read_b64_tr_b16 v[122:123], v8 offset:10240
    ds_read_b64_tr_b16 v[124:125], v9 offset:8192
    ds_read_b64_tr_b16 v[126:127], v9 offset:10240
L_wf_47:
    ds_read_b32 v15, v13 offset:28
    s_waitcnt lgkmcnt(0)
    v_readfirstlane_b32 s14, v15
    s_cmp_ge_u32 s14, 1
    s_cbranch_scc0 L_wf_47
    s_mov_b32 s61, s14
L_wf_48:
    ds_read_b32 v15, v13 offset:16
    s_waitcnt lgkmcnt(0)
    v_readfirstlane_b32 s14, v15
    s_cmp_ge_u32 s14, 1
    s_cbranch_scc0 L_wf_48
    ds_read_b128 v[16:19], v186 offset:0
    ds_read_b128 v[20:23], v187 offset:0
    ds_read_b128 v[24:27], v186 offset:64
    ds_read_b128 v[28:31], v187 offset:64
    ds_read_b128 v[32:35], v186 offset:128
    ds_read_b128 v[36:39], v187 offset:128
    ds_read_b128 v[40:43], v186 offset:192
    ds_read_b128 v[44:47], v187 offset:192
    s_waitcnt lgkmcnt(7)
    v_mfma_f32_16x16x32_bf16 v[48:51], v[80:83], v[16:19], 0
    v_mfma_f32_16x16x32_bf16 v[52:55], v[84:87], v[16:19], 0
    s_waitcnt lgkmcnt(6)
    v_mfma_f32_16x16x32_bf16 v[48:51], v[88:91], v[20:23], v[48:51]
    v_mfma_f32_16x16x32_bf16 v[52:55], v[92:95], v[20:23], v[52:55]
    s_waitcnt lgkmcnt(5)
    v_mfma_f32_16x16x32_bf16 v[48:51], v[96:99], v[24:27], v[48:51]
    v_mfma_f32_16x16x32_bf16 v[52:55], v[100:103], v[24:27], v[52:55]
    s_waitcnt lgkmcnt(4)
    v_mfma_f32_16x16x32_bf16 v[48:51], v[104:107], v[28:31], v[48:51]
    v_mfma_f32_16x16x32_bf16 v[52:55], v[108:111], v[28:31], v[52:55]
    s_waitcnt lgkmcnt(3)
    v_mfma_f32_16x16x32_bf16 v[48:51], v[112:115], v[32:35], v[48:51]
    v_mfma_f32_16x16x32_bf16 v[52:55], v[116:119], v[32:35], v[52:55]
    s_waitcnt lgkmcnt(2)
    v_mfma_f32_16x16x32_bf16 v[48:51], v[120:123], v[36:39], v[48:51]
    v_mfma_f32_16x16x32_bf16 v[52:55], v[124:127], v[36:39], v[52:55]
    s_waitcnt vmcnt(0)
    ds_read_b64_tr_b16 v[128:129], v6 offset:12288
    ds_read_b64_tr_b16 v[130:131], v6 offset:14336
    ds_read_b64_tr_b16 v[132:133], v7 offset:12288
    ds_read_b64_tr_b16 v[134:135], v7 offset:14336
    ds_read_b64_tr_b16 v[136:137], v8 offset:12288
    ds_read_b64_tr_b16 v[138:139], v8 offset:14336
    ds_read_b64_tr_b16 v[140:141], v9 offset:12288
    ds_read_b64_tr_b16 v[142:143], v9 offset:14336
    s_waitcnt lgkmcnt(6)
    v_mfma_f32_16x16x32_bf16 v[48:51], v[128:131], v[40:43], v[48:51]
    s_waitcnt lgkmcnt(4)
    v_mfma_f32_16x16x32_bf16 v[52:55], v[132:135], v[40:43], v[52:55]
    s_waitcnt lgkmcnt(2)
    v_mfma_f32_16x16x32_bf16 v[48:51], v[136:139], v[44:47], v[48:51]
    s_waitcnt lgkmcnt(0)
    v_mfma_f32_16x16x32_bf16 v[52:55], v[140:143], v[44:47], v[52:55]
    s_cmp_eq_u32 s61, 2
    s_nop 4
    v_cvt_pk_bf16_f32 v56, v48, v49
    v_cvt_pk_bf16_f32 v57, v50, v51
    v_cvt_pk_bf16_f32 v58, v52, v53
    v_cvt_pk_bf16_f32 v59, v54, v55
    v_min_u32 v56, -2, v56
    v_min_u32 v57, -2, v57
    v_min_u32 v58, -2, v58
    v_min_u32 v59, -2, v59
    s_cbranch_scc0 L_K_SLOWST
    buffer_store_dwordx4 v[56:59], v188, s[48:51], s59 offen
    s_branch L_K_STDONE
L_K_SLOWST:
    buffer_store_dwordx4 v[56:59], v188, s[48:51], s59 offen sc1
L_K_STDONE:
    s_mov_b64 exec, 1
    ds_add_u32 v13, v14 offset:20
    s_mov_b64 exec, -1
    s_cmp_eq_u32 s66, 1
    s_cselect_b32 s14, s11, 1
    s_cmp_eq_u32 s14, 0
    s_cbranch_scc1 L_K_FFN
    s_endpgm
L_SCORES:
    ds_read_b128 v[144:147], v10 offset:0
    ds_read_b128 v[148:151], v10 offset:64
    ds_read_b128 v[152:155], v10 offset:128
    ds_read_b128 v[156:159], v10 offset:192
    ds_read_b128 v[160:163], v10 offset:256
    ds_read_b128 v[164:167], v10 offset:320
    ds_read_b128 v[168:171], v10 offset:384
    ds_read_b128 v[172:175], v10 offset:448
    s_waitcnt lgkmcnt(7)
    v_mfma_f32_16x16x32_bf16 v[176:179], v[16:19], v[144:147], 0
    v_mfma_f32_16x16x32_bf16 v[180:183], v[48:51], v[144:147], 0
    s_waitcnt lgkmcnt(6)
    v_mfma_f32_16x16x32_bf16 v[176:179], v[20:23], v[148:151], v[176:179]
    v_mfma_f32_16x16x32_bf16 v[180:183], v[52:55], v[148:151], v[180:183]
    s_waitcnt lgkmcnt(5)
    v_mfma_f32_16x16x32_bf16 v[176:179], v[24:27], v[152:155], v[176:179]
    v_mfma_f32_16x16x32_bf16 v[180:183], v[56:59], v[152:155], v[180:183]
    s_waitcnt lgkmcnt(4)
    v_mfma_f32_16x16x32_bf16 v[176:179], v[28:31], v[156:159], v[176:179]
    v_mfma_f32_16x16x32_bf16 v[180:183], v[60:63], v[156:159], v[180:183]
    s_waitcnt lgkmcnt(3)
    v_mfma_f32_16x16x32_bf16 v[176:179], v[32:35], v[160:163], v[176:179]
    v_mfma_f32_16x16x32_bf16 v[180:183], v[64:67], v[160:163], v[180:183]
    s_waitcnt lgkmcnt(2)
    v_mfma_f32_16x16x32_bf16 v[176:179], v[36:39], v[164:167], v[176:179]
    v_mfma_f32_16x16x32_bf16 v[180:183], v[68:71], v[164:167], v[180:183]
    s_waitcnt lgkmcnt(1)
    v_mfma_f32_16x16x32_bf16 v[176:179], v[40:43], v[168:171], v[176:179]
    v_mfma_f32_16x16x32_bf16 v[180:183], v[72:75], v[168:171], v[180:183]
    s_waitcnt lgkmcnt(0)
    v_mfma_f32_16x16x32_bf16 v[176:179], v[44:47], v[172:175], v[176:179]
    v_mfma_f32_16x16x32_bf16 v[180:183], v[76:79], v[172:175], v[180:183]
    s_mov_b32 s60, 1
    s_nop 6
    v_cvt_pk_bf16_f32 v144, v176, v177
    v_cvt_pk_bf16_f32 v145, v178, v179
    v_cvt_pk_bf16_f32 v146, v180, v181
    v_cvt_pk_bf16_f32 v147, v182, v183
    s_mov_b32 exec_lo, 0x00030003
    s_mov_b32 exec_hi, 0x00030003
    ds_write_b128 v12, v[144:147]
    s_mov_b64 exec, 1
    ds_add_u32 v13, v14 offset:12
    s_mov_b64 exec, -1
    s_setpc_b64 s[64:65]
L_S0_TAG:
L_S0_GATHER:
L_wf_49:
    s_sleep 2
    ds_read_b32 v24, v2 offset:0
    s_waitcnt lgkmcnt(0)
    v_readfirstlane_b32 s14, v24
    s_cmp_ge_u32 s14, 1
    s_cbranch_scc0 L_wf_49
    s_mov_b32 s68, s14
    s_lshl_b32 s56, s10, 11
    s_add_u32 s56, s56, 8192
    v_lshlrev_b32 v7, 3, v0
    v_xor_b32 v7, s70, v7
    v_add_u32 v7, 155392, v7
L_wf_50:
    s_sleep 1
    ds_read_b32 v24, v2 offset:24
    s_waitcnt lgkmcnt(0)
    v_readfirstlane_b32 s14, v24
    s_cmp_ge_u32 s14, 4
    s_cbranch_scc0 L_wf_50
    s_add_u32 s57, s56, 974848
    s_mov_b32 s13, 1
L_QPOLL:
    s_and_b32 s14, s13, 7
    s_cselect_b32 s58, s57, s56
    buffer_load_dwordx4 v[8:11], v4, s[48:51], s58 offen sc1
    buffer_load_dwordx4 v[12:15], v4, s[48:51], s58 offen offset:1024 sc1
    s_waitcnt vmcnt(0)
    v_xor_b32 v9, s68, v9
    v_xor_b32 v11, s68, v11
    v_xor_b32 v13, s68, v13
    v_xor_b32 v15, s68, v15
    v_or3_b32 v9, v9, v11, v13
    v_or_b32 v9, v9, v15
    v_cmp_ne_u32 vcc, 0, v9
    s_cbranch_vccz L_QOK
    s_add_u32 s13, s13, 1
    s_cmp_lt_u32 s13, 1048576
    s_cbranch_scc1 L_QPOLL
L_QOK:
    v_mov_b32 v9, v10
    v_mov_b32 v13, v14
    ds_write_b64 v7, v[8:9]
    ds_write_b64 v7, v[12:13] offset:576
    s_mov_b64 exec, 1
    ds_add_u32 v2, v3 offset:8
    s_mov_b64 exec, -1
    s_cmp_eq_u32 s66, 3
    s_cbranch_scc1 L_STAGE2
    s_cmp_eq_u32 s66, 1
    s_cbranch_scc1 L_FFN
    s_endpgm
L_S1_SM:
    v_lshrrev_b32 v6, 5, v0
    v_mul_u32_u24 v6, 320, v6
    v_and_b32 v7, 31, v0
    v_lshl_add_u32 v6, v7, 3, v6
    v_add_u32 v6, 156544, v6
    v_cmp_gt_u32 s[58:59], 32, v0
    s_mov_b32 s61, 0x3db8aa3b
    s_lshr_b32 s56, s8, 1
    s_lshl_b32 s56, s56, 8
    s_and_b32 s57, s5, 15
    s_lshl_b32 s57, s57, 3
    s_add_u32 s56, s56, s57
    s_add_u32 s56, s56, 491520
    v_lshrrev_b32 v7, 5, v0
    v_lshlrev_b32 v7, 7, v7
    s_waitcnt vmcnt(0)
L_wf_51:
    s_sleep 1
    ds_read_b32 v24, v2 offset:12
    s_waitcnt lgkmcnt(0)
    v_readfirstlane_b32 s14, v24
    s_cmp_ge_u32 s14, 4
    s_cbranch_scc0 L_wf_51
    ds_read_b64 v[8:9], v6
    s_waitcnt lgkmcnt(0)
    v_lshlrev_b32 v12, 16, v8
    v_and_b32 v13, 0xffff0000, v8
    v_lshlrev_b32 v14, 16, v9
    v_and_b32 v15, 0xffff0000, v9
    v_max3_f32 v16, v12, v13, v14
    v_max_f32 v16, v16, v15
    s_nop 1
    v_max_f32_dpp v16, v16, v16 row_shr:1 row_mask:0xf bank_mask:0xf
    s_nop 1
    v_max_f32_dpp v16, v16, v16 row_shr:2 row_mask:0xf bank_mask:0xf
    s_nop 1
    v_max_f32_dpp v16, v16, v16 row_shr:4 row_mask:0xf bank_mask:0xf
    s_nop 1
    v_max_f32_dpp v16, v16, v16 row_shr:8 row_mask:0xf bank_mask:0xf
    s_nop 1
    v_max_f32_dpp v16, v16, v16 row_bcast:15 row_mask:0xa bank_mask:0xf
    s_nop 0
    v_readlane_b32 s64, v16, 31
    v_readlane_b32 s65, v16, 63
    s_nop 1
    v_mov_b32 v20, s64
    v_mov_b32 v22, s65
    v_mul_f32 v20, s61, v20
    v_mul_f32 v22, s61, v22
    v_cndmask_b32 v18, v22, v20, s[58:59]
    v_fma_f32 v12, v12, s61, -v18
    v_fma_f32 v13, v13, s61, -v18
    v_fma_f32 v14, v14, s61, -v18
    v_fma_f32 v15, v15, s61, -v18
    v_exp_f32 v12, v12
    v_exp_f32 v13, v13
    v_exp_f32 v14, v14
    v_exp_f32 v15, v15
    s_nop 0
    v_cvt_pk_bf16_f32 v8, v12, v13
    v_cvt_pk_bf16_f32 v9, v14, v15
    ds_write_b64 v6, v[8:9] offset:640
    s_mov_b64 exec, 1
    ds_add_u32 v2, v3 offset:16
    s_mov_b64 exec, -1
    v_add_f32 v19, v12, v13
    v_add_f32 v17, v14, v15
    v_add_f32 v19, v19, v17
    s_nop 1
    v_add_f32_dpp v19, v19, v19 row_shr:1 row_mask:0xf bank_mask:0xf
    s_nop 1
    v_add_f32_dpp v19, v19, v19 row_shr:2 row_mask:0xf bank_mask:0xf
    s_nop 1
    v_add_f32_dpp v19, v19, v19 row_shr:4 row_mask:0xf bank_mask:0xf
    s_nop 1
    v_add_f32_dpp v19, v19, v19 row_shr:8 row_mask:0xf bank_mask:0xf
    s_nop 1
    v_add_f32_dpp v19, v19, v19 row_bcast:15 row_mask:0xa bank_mask:0xf
    s_nop 0
    v_min_u32 v18, -2, v18
    v_min_u32 v19, -2, v19
L_wf_52:
    ds_read_b32 v24, v2 offset:28
    s_waitcnt lgkmcnt(0)
    v_readfirstlane_b32 s14, v24
    s_cmp_ge_u32 s14, 1
    s_cbranch_scc0 L_wf_52
    s_mov_b32 exec_lo, 0x80000000
    s_mov_b32 exec_hi, 0x80000000
    s_cmp_eq_u32 s14, 2
    s_cbranch_scc0 L_S1_SLOW
    buffer_store_dwordx2 v[18:19], v7, s[48:51], s56 offen
    s_branch L_S1_DONE
L_S1_SLOW:
    buffer_store_dwordx2 v[18:19], v7, s[48:51], s56 offen sc1
L_S1_DONE:
    s_mov_b64 exec, -1
    s_cmp_eq_u32 s66, 3
    s_cbranch_scc1 L_STAGE2
    s_cmp_eq_u32 s66, 1
    s_cbranch_scc1 L_FFN
    s_endpgm
L_S2_FLAG:
    s_lshl_b32 s56, s4, 12
    s_lshl_b32 s57, s5, 7
    s_add_u32 s57, s57, s56
    s_add_u32 s57, s57, 458752
    s_lshl_b32 s58, s4, 8
    s_lshl_b32 s59, s5, 3
    s_add_u32 s59, s59, s58
    s_add_u32 s59, s59, 6144
    s_waitcnt vmcnt(0)
    s_mov_b64 exec, 1
    buffer_store_dwordx2 v[20:21], v19, s[48:51], s59 offen
    buffer_store_dwordx2 v[20:21], v19, s[48:51], s57 offen sc1
    s_mov_b64 exec, -1
    s_cmp_lg_u32 s66, 0
    s_cbranch_scc1 L_S2_NOQ
    s_call_b64 s[64:65], L_QPART
L_S2_NOQ:
    s_lshl_b32 s56, s4, 12
    s_add_u32 s56, s56, 458752
    s_lshl_b32 s58, s4, 8
    s_add_u32 s58, s58, 6144
    v_and_b32 v16, 31, v0
    v_lshlrev_b32 v17, 3, v16
    v_lshlrev_b32 v16, 7, v16
    s_sub_u32 s59, s58, 4096
    s_cmp_eq_u32 s5, 31
    s_cselect_b32 s59, s59, 1073741824
L_wf_53:
    s_sleep 2
    ds_read_b32 v24, v2 offset:24
    s_waitcnt lgkmcnt(0)
    v_readfirstlane_b32 s14, v24
    s_cmp_ge_u32 s14, 1
    s_cbranch_scc0 L_wf_53
    s_cmp_eq_u32 s5, 31
    s_cbranch_scc0 L_GSTART
L_wf_54:
    s_sleep 2
    ds_read_b32 v24, v2 offset:40
    s_waitcnt lgkmcnt(0)
    v_readfirstlane_b32 s14, v24
    s_cmp_ge_u32 s14, 1
    s_cbranch_scc0 L_wf_54
L_GSTART:
    s_mov_b32 s13, 1
L_GPOLL:
    buffer_load_dwordx2 v[14:15], v17, s[48:51], s59 offen sc1
    s_and_b32 s14, s13, 7
    s_cbranch_scc0 L_GSLOW
    buffer_load_dwordx2 v[12:13], v17, s[48:51], s58 offen sc1
    s_branch L_GCHK
L_GSLOW:
    buffer_load_dwordx2 v[12:13], v16, s[48:51], s56 offen sc1
L_GCHK:
    s_waitcnt vmcnt(0)
    v_cmp_ne_u32 vcc, s68, v12
    s_cbranch_vccz L_GOK
    s_sleep 2
    s_add_u32 s13, s13, 1
    s_cmp_lt_u32 s13, 1048576
    s_cbranch_scc1 L_GPOLL
L_GOK:
    v_cmp_ne_u32 vcc, s69, v13
    s_cmp_eq_u64 vcc, 0
    s_cselect_b32 s14, 2, 1
    v_mov_b32 v21, s14
    s_mov_b64 exec, 1
    ds_write_b32 v2, v21 offset:28
    s_mov_b64 exec, -1
    s_cmp_eq_u32 s5, 31
    s_cbranch_scc0 L_S2_NOLEAD
    v_cmp_eq_u32 vcc, s68, v14
    s_lshl_b32 s58, s4, 7
    s_add_u32 s58, s58, 4096
    v_cndmask_b32 v15, 0, v15, vcc
    s_nop 1
    v_add_u32_dpp v15, v15, v15 row_shr:1 row_mask:0xf bank_mask:0xf
    s_nop 1
    v_add_u32_dpp v15, v15, v15 row_shr:2 row_mask:0xf bank_mask:0xf
    s_nop 1
    v_add_u32_dpp v15, v15, v15 row_shr:4 row_mask:0xf bank_mask:0xf
    s_nop 1
    v_add_u32_dpp v15, v15, v15 row_shr:8 row_mask:0xf bank_mask:0xf
    s_nop 1
    v_add_u32_dpp v15, v15, v15 row_bcast:15 row_mask:0xa bank_mask:0xf
    s_nop 1
    v_add_u32_dpp v15, v15, v15 row_bcast:31 row_mask:0xc bank_mask:0xf
    s_nop 0
    v_readlane_b32 s14, v15, 63
    s_sub_i32 s13, 0, s14
    s_bitcmp1_b32 s69, 2
    s_cselect_b32 s14, s13, s14
    v_mov_b32 v21, s14
    s_mov_b64 exec, 1
    buffer_store_dwordx2 v[20:21], v19, s[48:51], s58 offen sc1
    s_mov_b64 exec, -1
L_S2_NOLEAD:
    s_cmp_eq_u32 s66, 3
    s_cbranch_scc1 L_STAGE2
    s_cmp_eq_u32 s66, 2
    s_cbranch_scc1 L_RED_END
    v_and_b32 v16, 7, v0
    v_lshlrev_b32 v16, 7, v16
    s_mov_b32 s56, 4096
L_wf_55:
    s_sleep 2
    ds_read_b32 v24, v2 offset:8
    s_waitcnt lgkmcnt(0)
    v_readfirstlane_b32 s14, v24
    s_cmp_ge_u32 s14, 1
    s_cbranch_scc0 L_wf_55
    s_mov_b32 s13, 0
L_APOLL:
    buffer_load_dwordx2 v[12:13], v16, s[48:51], s56 offen sc1
    s_waitcnt vmcnt(0)
    v_cmp_ne_u32 vcc, s68, v12
    s_cbranch_vccz L_AOK
    s_sleep 4
    s_add_u32 s13, s13, 1
    s_cmp_lt_u32 s13, 1048576
    s_cbranch_scc1 L_APOLL
L_AOK:
    s_nop 1
    v_add_u32_dpp v13, v13, v13 quad_perm:[1,0,3,2] row_mask:0xf bank_mask:0xf
    s_nop 1
    v_add_u32_dpp v13, v13, v13 quad_perm:[2,3,0,1] row_mask:0xf bank_mask:0xf
    s_nop 1
    v_add_u32_dpp v13, v13, v13 row_half_mirror row_mask:0xf bank_mask:0xf
    s_getreg_b32 s13, hwreg(HW_REG_XCC_ID, 2, 1)
    v_readfirstlane_b32 s14, v13
    s_cmp_gt_i32 s14, 0
    s_cselect_b32 s14, 1, 0
    s_xor_b32 s14, s14, s13
    s_add_u32 s14, s14, 1
    v_mov_b32 v15, s14
    s_mov_b64 exec, 1
    ds_write_b32 v2, v15 offset:44
    s_mov_b64 exec, -1
    s_cmp_eq_u32 s66, 1
    s_cbranch_scc1 L_FFN
    s_branch L_RED
L_S3_PF:
    s_sub_u32 s58, s5, 21
    s_cmp_lt_u32 s5, 8
    s_cselect_b32 s58, s5, s58
    v_lshrrev_b32 v6, 2, v0
    v_mul_u32_u24 v6, 3584, v6
    v_and_b32 v7, 3, v0
    v_lshl_add_u32 v6, v7, 7, v6
    s_mul_i32 s56, s4, 448
    s_and_b32 s56, s56, 0xffffff80
    v_lshlrev_b32 v7, 7, v0
    s_mov_b32 s40, s28
    s_mov_b32 s41, s29
    s_mov_b32 s42, 1605632
    s_mov_b32 s43, 0x20000
    s_mov_b32 s44, s30
    s_mov_b32 s45, s31
    s_mov_b32 s46, 1605632
    s_mov_b32 s47, 0x20000
    s_mul_i32 s57, s58, 114688
    s_add_u32 s56, s56, s57
    s_add_u32 s56, s56, 344064
    s_mul_i32 s57, s4, 200704
    s_add_u32 s52, s32, s57
    s_addc_u32 s53, s33, 0
    s_mov_b32 s54, 200704
    s_mov_b32 s55, 0x20000
    s_mul_i32 s57, s58, 24576
L_wf_56:
    s_sleep 1
    ds_read_b32 v24, v2 offset:20
    s_waitcnt lgkmcnt(0)
    v_readfirstlane_b32 s14, v24
    s_cmp_ge_u32 s14, 4
    s_cbranch_scc0 L_wf_56
    buffer_load_dword v12, v6, s[40:43], s56 offen
    buffer_load_dword v13, v6, s[44:47], s56 offen
    s_add_u32 s56, s56, 57344
    buffer_load_dword v14, v6, s[40:43], s56 offen
    buffer_load_dword v15, v6, s[44:47], s56 offen
    s_add_u32 s56, s56, 57344
    buffer_load_dword v24, v7, s[52:55], s57 offen
    s_add_u32 s57, s57, 8192
    buffer_load_dword v25, v7, s[52:55], s57 offen
    s_add_u32 s57, s57, 8192
    buffer_load_dword v26, v7, s[52:55], s57 offen
    s_add_u32 s57, s57, 8192
    s_endpgm
L_K_FFN:
    v_bfe_u32 v16, v0, 3, 2
    v_lshrrev_b32 v18, 5, v0
    v_and_b32 v17, 0x70, v3
    v_lshl_add_u32 v24, v18, 3, v16
    v_mul_u32_u24 v24, 896, v24
    v_add_u32 v24, v24, v17
    v_add_u32 v25, 14336, v24
    v_add_u32 v26, 3584, v24
    v_add_u32 v27, 17920, v24
    v_lshrrev_b32 v22, 2, v0
    v_mul_u32_u24 v20, 3584, v22
    v_and_b32 v23, 3, v0
    v_xor_b32 v23, v23, v18
    v_lshl_add_u32 v20, v23, 4, v20
    v_xor_b32 v21, 32, v20
    s_mul_i32 s62, s4, 7
    s_add_u32 s62, s62, s5
    s_sub_u32 s62, s62, 22
    s_lshl_b32 s56, s62, 6
    s_add_u32 s40, s28, s56
    s_addc_u32 s41, s29, 0
    s_mov_b32 s42, 1602112
    s_mov_b32 s43, 0x20000
    s_add_u32 s44, s30, s56
    s_addc_u32 s45, s31, 0
    s_mov_b32 s46, 1602112
    s_mov_b32 s47, 0x20000
    s_mul_i32 s56, s62, 28672
    s_add_u32 s52, s32, s56
    s_addc_u32 s53, s33, 0
    s_mov_b32 s54, 28672
    s_mov_b32 s55, 0x20000
    s_mov_b32 m0, 65536
    s_movk_i32 s15, 0
L_wf_57:
    ds_read_b32 v28, v13 offset:20
    s_waitcnt lgkmcnt(0)
    v_readfirstlane_b32 s14, v28
    s_cmp_ge_u32 s14, 4
    s_cbranch_scc0 L_wf_57
    s_movk_i32 s13, 28
L_tl_58:
    buffer_load_dwordx4 v20, s[40:43], s15 offen nt lds
    s_addk_i32 m0, 28672
    s_waitcnt vmcnt(31)
    buffer_load_dwordx4 v21, s[44:47], s15 offen nt lds
    s_addk_i32 m0, -27648
    s_waitcnt vmcnt(31)
    s_add_u32 s15, s15, 57344
    s_sub_u32 s13, s13, 1
    s_cmp_lg_u32 s13, 0
    s_cbranch_scc1 L_tl_58
    s_mov_b32 m0, 122880
    s_movk_i32 s15, 0
    s_movk_i32 s13, 7
L_tl_59:
    buffer_load_dwordx4 v24, s[52:55], s15 offen nt lds
    s_addk_i32 m0, 1024
    s_nop 0
    buffer_load_dwordx4 v25, s[52:55], s15 offen nt lds
    s_addk_i32 m0, 1024
    s_nop 0
    buffer_load_dwordx4 v26, s[52:55], s15 offen nt lds
    s_addk_i32 m0, 1024
    s_nop 0
    buffer_load_dwordx4 v27, s[52:55], s15 offen nt lds
    s_addk_i32 m0, 1024
    s_nop 0
    s_add_u32 s15, s15, 128
    s_sub_u32 s13, s13, 1
    s_cmp_lg_u32 s13, 0
    s_cbranch_scc1 L_tl_59
    s_waitcnt vmcnt(28)
    s_mov_b64 exec, 1
    ds_add_u32 v13, v14 offset:32
    s_mov_b64 exec, -1
    s_waitcnt vmcnt(0)
    s_mov_b64 exec, 1
    ds_add_u32 v13, v14 offset:32
    s_mov_b64 exec, -1
    s_endpgm
L_STAGE2:
    s_lshr_b32 s70, s11, 1
    s_and_b32 s71, s11, 1
    s_lshl_b32 s71, s71, 1
    s_sub_u32 s64, s5, 8
    s_and_b32 s65, s64, 1
    s_lshr_b32 s64, s64, 1
    s_lshl_b32 s12, s70, 14
    s_add_u32 s12, s12, 65536
    v_lshrrev_b32 v24, 2, v0
    v_bfe_u32 v25, v0, 3, 2
    v_and_b32 v26, 3, v0
    v_lshlrev_b32 v24, 7, v24
    v_lshl_add_u32 v24, v26, 3, v24
    v_add_u32 v24, s12, v24
    v_xor_b32 v26, 0, v25
    v_lshl_add_u32 v12, v26, 5, v24
    v_xor_b32 v26, 1, v25
    v_lshl_add_u32 v13, v26, 5, v24
    v_xor_b32 v26, 2, v25
    v_lshl_add_u32 v14, v26, 5, v24
    v_xor_b32 v26, 3, v25
    v_lshl_add_u32 v15, v26, 5, v24
    v_and_b32 v24, 7, v0
    v_lshrrev_b32 v25, 4, v0
    v_bfe_u32 v26, v0, 3, 1
    v_and_b32 v17, 15, v0
    v_lshlrev_b32 v17, 3, v17
    v_lshlrev_b32 v18, 4, v24
    v_lshl_add_u32 v18, v26, 12, v18
    v_lshrrev_b32 v27, 5, v0
    v_mul_u32_u24 v27, 114688, v27
    v_add_u32 v18, v18, v27
    v_and_b32 v27, 1, v25
    v_lshl_add_u32 v18, v27, 13, v18
    v_lshlrev_b32 v19, 4, v25
    s_add_u32 s56, s9, s71
    s_lshl_b32 s57, s56, 7
    s_lshl_b32 s14, s65, 7
    s_add_u32 s57, s57, s14
    s_add_u32 s57, s57, 491520
    s_lshl_b32 s14, s65, 1
    s_add_u32 s14, s14, s70
    s_lshl_b32 s56, s56, 1
    s_add_u32 s56, s56, s14
    s_lshl_b32 s56, s56, 12
    s_add_u32 s56, s56, 131072
    s_add_u32 s14, s14, s9
    s_lshl_b32 s14, s14, 7
    s_mul_i32 s60, s71, 7
    s_add_u32 s60, s60, s64
    s_lshl_b32 s60, s60, 14
    s_add_u32 s60, s60, s14
    s_add_u32 s60, s60, 524288
L_wf_60:
    s_sleep 1
    ds_read_b32 v24, v2 offset:32
    s_waitcnt lgkmcnt(0)
    v_readfirstlane_b32 s14, v24
    s_cmp_ge_u32 s14, 1
    s_cbranch_scc0 L_wf_60
    ds_read_b64_tr_b16 v[48:49], v12 offset:0
    ds_read_b64_tr_b16 v[50:51], v12 offset:2048
    ds_read_b64_tr_b16 v[52:53], v13 offset:0
    ds_read_b64_tr_b16 v[54:55], v13 offset:2048
    ds_read_b64_tr_b16 v[56:57], v14 offset:0
    ds_read_b64_tr_b16 v[58:59], v14 offset:2048
    ds_read_b64_tr_b16 v[60:61], v15 offset:0
    ds_read_b64_tr_b16 v[62:63], v15 offset:2048
    s_waitcnt lgkmcnt(0)
    ds_read_b64_tr_b16 v[64:65], v12 offset:4096
    ds_read_b64_tr_b16 v[66:67], v12 offset:6144
    ds_read_b64_tr_b16 v[68:69], v13 offset:4096
    ds_read_b64_tr_b16 v[70:71], v13 offset:6144
    ds_read_b64_tr_b16 v[72:73], v14 offset:4096
    ds_read_b64_tr_b16 v[74:75], v14 offset:6144
    ds_read_b64_tr_b16 v[76:77], v15 offset:4096
    ds_read_b64_tr_b16 v[78:79], v15 offset:6144
    s_waitcnt lgkmcnt(0)
    ds_read_b64_tr_b16 v[80:81], v12 offset:8192
    ds_read_b64_tr_b16 v[82:83], v12 offset:10240
    ds_read_b64_tr_b16 v[84:85], v13 offset:8192
    ds_read_b64_tr_b16 v[86:87], v13 offset:10240
    ds_read_b64_tr_b16 v[88:89], v14 offset:8192
    ds_read_b64_tr_b16 v[90:91], v14 offset:10240
    ds_read_b64_tr_b16 v[92:93], v15 offset:8192
    ds_read_b64_tr_b16 v[94:95], v15 offset:10240
    s_waitcnt lgkmcnt(0)
    ds_read_b64_tr_b16 v[96:97], v12 offset:12288
    ds_read_b64_tr_b16 v[98:99], v12 offset:14336
    ds_read_b64_tr_b16 v[100:101], v13 offset:12288
    ds_read_b64_tr_b16 v[102:103], v13 offset:14336
    ds_read_b64_tr_b16 v[104:105], v14 offset:12288
    ds_read_b64_tr_b16 v[106:107], v14 offset:14336
    ds_read_b64_tr_b16 v[108:109], v15 offset:12288
    ds_read_b64_tr_b16 v[110:111], v15 offset:14336
    s_waitcnt lgkmcnt(0)
L_wf_61:
    s_sleep 1
    ds_read_b32 v24, v2 offset:28
    s_waitcnt lgkmcnt(0)
    v_readfirstlane_b32 s14, v24
    s_cmp_ge_u32 s14, 1
    s_cbranch_scc0 L_wf_61
    s_mov_b32 s13, 0
L_OPOLL:
    buffer_load_dwordx2 v[20:21], v17, s[48:51], s57 offen sc1
    buffer_load_dwordx4 v[112:115], v4, s[48:51], s56 offen offset:0 sc1
    buffer_load_dwordx4 v[116:119], v4, s[48:51], s56 offen offset:1024 sc1
    buffer_load_dwordx4 v[120:123], v4, s[48:51], s56 offen offset:2048 sc1
    buffer_load_dwordx4 v[124:127], v4, s[48:51], s56 offen offset:3072 sc1
    s_waitcnt vmcnt(4)
    v_max_u32 v24, v20, v21
    s_waitcnt vmcnt(3)
    v_max3_u32 v24, v24, v112, v113
    v_max3_u32 v24, v24, v114, v115
    s_waitcnt vmcnt(2)
    v_max3_u32 v24, v24, v116, v117
    v_max3_u32 v24, v24, v118, v119
    s_waitcnt vmcnt(1)
    v_max3_u32 v24, v24, v120, v121
    v_max3_u32 v24, v24, v122, v123
    s_waitcnt vmcnt(0)
    v_max3_u32 v24, v24, v124, v125
    v_max3_u32 v24, v24, v126, v127
    v_cmp_eq_u32 vcc, -1, v24
    s_cbranch_vccz L_OOK
    s_cmp_lg_u32 s13, 0
    s_cbranch_scc1 L_ONEXT
L_wf_62:
    s_sleep 1
    ds_read_b32 v24, v2 offset:20
    s_waitcnt lgkmcnt(0)
    v_readfirstlane_b32 s14, v24
    s_cmp_ge_u32 s14, 1
    s_cbranch_scc0 L_wf_62
L_ONEXT:
    s_add_u32 s13, s13, 1
    s_cmp_lt_u32 s13, 1048576
    s_cbranch_scc1 L_OPOLL
L_OOK:
    v_mfma_f32_16x16x32_bf16 v[128:131], v[112:115], v[48:51], 0
    v_max_f32_dpp v22, v20, v20 quad_perm:[1,0,3,2] row_mask:0xf bank_mask:0xf
    v_mfma_f32_16x16x32_bf16 v[128:131], v[116:119], v[64:67], v[128:131]
    s_nop 0
    v_max_f32_dpp v22, v22, v22 quad_perm:[2,3,0,1] row_mask:0xf bank_mask:0xf
    v_mfma_f32_16x16x32_bf16 v[128:131], v[120:123], v[80:83], v[128:131]
    s_nop 0
    v_max_f32_dpp v22, v22, v22 row_half_mirror row_mask:0xf bank_mask:0xf
    v_sub_f32 v20, v20, v22
    v_exp_f32 v20, v20
    v_mfma_f32_16x16x32_bf16 v[128:131], v[124:127], v[96:99], v[128:131]
    v_mul_f32 v22, v20, v21
    v_mfma_f32_16x16x32_bf16 v[132:135], v[112:115], v[52:55], 0
    s_nop 0
    v_add_f32_dpp v22, v22, v22 quad_perm:[1,0,3,2] row_mask:0xf bank_mask:0xf
    v_mfma_f32_16x16x32_bf16 v[132:135], v[116:119], v[68:71], v[132:135]
    s_nop 0
    v_add_f32_dpp v22, v22, v22 quad_perm:[2,3,0,1] row_mask:0xf bank_mask:0xf
    v_mfma_f32_16x16x32_bf16 v[132:135], v[120:123], v[84:87], v[132:135]
    s_nop 0
    v_add_f32_dpp v22, v22, v22 row_half_mirror row_mask:0xf bank_mask:0xf
    v_rcp_f32 v22, v22
    v_mfma_f32_16x16x32_bf16 v[132:135], v[124:127], v[100:103], v[132:135]
    v_mul_f32 v20, v20, v22
    ds_bpermute_b32 v28, v19, v20 offset:0
    ds_bpermute_b32 v29, v19, v20 offset:4
    ds_bpermute_b32 v30, v19, v20 offset:8
    ds_bpermute_b32 v31, v19, v20 offset:12
    v_mfma_f32_16x16x32_bf16 v[136:139], v[112:115], v[56:59], 0
    v_mfma_f32_16x16x32_bf16 v[136:139], v[116:119], v[72:75], v[136:139]
    v_mfma_f32_16x16x32_bf16 v[136:139], v[120:123], v[88:91], v[136:139]
    v_mfma_f32_16x16x32_bf16 v[136:139], v[124:127], v[104:107], v[136:139]
    v_mfma_f32_16x16x32_bf16 v[140:143], v[112:115], v[60:63], 0
    s_waitcnt lgkmcnt(0)
    v_pk_mul_f32 v[128:129], v[128:129], v[28:29]
    v_mfma_f32_16x16x32_bf16 v[140:143], v[116:119], v[76:79], v[140:143]
    v_pk_fma_f32 v[128:129], v[130:131], v[30:31], v[128:129]
    v_mfma_f32_16x16x32_bf16 v[140:143], v[120:123], v[92:95], v[140:143]
    v_add_f32 v24, v128, v129
    v_mfma_f32_16x16x32_bf16 v[140:143], v[124:127], v[108:111], v[140:143]
    v_pk_mul_f32 v[132:133], v[132:133], v[28:29]
    v_pk_fma_f32 v[132:133], v[134:135], v[30:31], v[132:133]
    v_add_f32 v25, v132, v133
    v_pk_mul_f32 v[136:137], v[136:137], v[28:29]
    v_pk_fma_f32 v[136:137], v[138:139], v[30:31], v[136:137]
    v_add_f32 v26, v136, v137
    v_permlane16_swap_b32 v24, v25
    v_add_f32 v24, v24, v25
    v_pk_mul_f32 v[140:141], v[140:141], v[28:29]
    v_pk_fma_f32 v[140:141], v[142:143], v[30:31], v[140:141]
    v_add_f32 v27, v140, v141
    v_min_u32 v24, -2, v24
    v_mov_b32 v25, v24
    v_permlane16_swap_b32 v26, v27
    v_add_f32 v26, v26, v27
    v_permlane16_swap_b32 v24, v25
    v_min_u32 v26, -2, v26
    v_mov_b32 v27, v26
    s_nop 1
    v_permlane16_swap_b32 v26, v27
    buffer_store_dwordx4 v[24:27], v18, s[48:51], s60 offen sc1
    s_mul_i32 s63, s11, 14
    s_add_u32 s63, s63, s5
    s_sub_u32 s63, s63, 8
    s_cmp_lg_u32 s4, 0
    s_cselect_b32 s63, 99, s63
    s_cmp_ge_u32 s63, 32
    s_cbranch_scc1 L_RED_END
    s_lshr_b32 s64, s63, 3
    s_bfe_u32 s65, s63, 0x20001
    s_and_b32 s70, s63, 1
    v_bfe_u32 v8, v0, 2, 1
    v_bfe_u32 v9, v0, 3, 1
    v_lshl_add_u32 v8, v8, 1, v9
    v_and_b32 v10, 1, v0
    v_lshlrev_b32 v10, 4, v10
    v_mov_b32 v11, 0x3f80
    v_lshlrev_b32 v11, v10, v11
    v_cmp_eq_u32 vcc, 0, v8
    s_nop 1
    v_cndmask_b32 v32, 0, v11, vcc
    v_cmp_eq_u32 vcc, 1, v8
    s_nop 1
    v_cndmask_b32 v33, 0, v11, vcc
    v_cmp_eq_u32 vcc, 2, v8
    s_nop 1
    v_cndmask_b32 v34, 0, v11, vcc
    v_cmp_eq_u32 vcc, 3, v8
    s_nop 1
    v_cndmask_b32 v35, 0, v11, vcc
    v_bfe_u32 v12, v0, 4, 1
    v_lshrrev_b32 v13, 5, v0
    v_lshl_add_u32 v13, v13, 1, v9
    v_and_b32 v14, 7, v0
    v_lshlrev_b32 v15, 8, v12
    v_lshl_add_u32 v15, v13, 4, v15
    v_and_b32 v16, 6, v14
    v_lshl_add_u32 v15, v16, 1, v15
    v_lshlrev_b32 v17, 7, v12
    v_lshl_add_u32 v17, v13, 5, v17
    v_lshl_add_u32 v17, v14, 1, v17
    s_cmp_eq_u32 s65, 3
    s_cselect_b32 s14, 1, 2
    v_cmp_gt_u32 vcc, s14, v12
    v_mov_b32 v16, 1073741824
    v_cmp_eq_u32 s[58:59], 0, v9
    v_cndmask_b32 v15, v16, v15, vcc
    v_cndmask_b32 v17, v16, v17, vcc
    s_mul_i32 s56, s64, 14
    s_lshl_b32 s14, s65, 2
    s_add_u32 s56, s56, s14
    s_add_u32 s56, s56, s70
    s_lshl_b32 s56, s56, 7
    s_add_u32 s56, s56, 393216
    s_mul_i32 s69, s64, 896
    s_lshl_b32 s14, s65, 8
    s_add_u32 s69, s69, s14
    s_lshl_b32 s14, s70, 4
    s_add_u32 s69, s69, s14
    s_lshl_b32 s60, s63, 14
    s_add_u32 s60, s60, 1040384
    s_mov_b32 s44, s34
    s_mov_b32 s45, s35
    s_mov_b32 s46, 3584
    s_mov_b32 s47, 0x20000
L_wf_63:
    ds_read_b32 v24, v2 offset:0
    s_waitcnt lgkmcnt(0)
    v_readfirstlane_b32 s14, v24
    s_cmp_ge_u32 s14, 1
    s_cbranch_scc0 L_wf_63
    s_mov_b32 s68, s14
    v_lshlrev_b32 v16, 7, v14
    s_mov_b32 s57, 4096
    s_mov_b32 s13, 0
L_FGPOLL:
    buffer_load_dwordx2 v[18:19], v16, s[48:51], s57 offen sc1
    s_waitcnt vmcnt(0)
    v_cmp_ne_u32 vcc, s68, v18
    s_cbranch_vccz L_FGOK
    s_sleep 2
    s_add_u32 s13, s13, 1
    s_cmp_lt_u32 s13, 1048576
    s_cbranch_scc1 L_FGPOLL
L_FGOK:
    s_nop 1
    v_add_u32_dpp v19, v19, v19 quad_perm:[1,0,3,2] row_mask:0xf bank_mask:0xf
    s_nop 1
    v_add_u32_dpp v19, v19, v19 quad_perm:[2,3,0,1] row_mask:0xf bank_mask:0xf
    s_nop 1
    v_add_u32_dpp v19, v19, v19 row_half_mirror row_mask:0xf bank_mask:0xf
    s_getreg_b32 s13, hwreg(HW_REG_XCC_ID, 2, 1)
    v_readfirstlane_b32 s14, v19
    s_cmp_gt_i32 s14, 0
    s_cselect_b32 s14, 1, 0
    s_xor_b32 s14, s14, s13
    s_add_u32 s14, s14, 1
    s_lshl_b32 s14, s14, 13
    s_add_u32 s60, s60, s14
    s_add_u32 s61, s60, 4096
    s_add_u32 s56, s56, s14
    s_sub_u32 s56, s56, 8192
    s_mov_b32 s13, 0
L_FHPOLL:
    buffer_load_dword v18, v15, s[48:51], s56 offen sc1
    s_waitcnt vmcnt(0)
    v_cmp_eq_u32 vcc, -1, v18
    s_cbranch_vccz L_FHOK
    s_sleep 2
    s_add_u32 s13, s13, 1
    s_cmp_lt_u32 s13, 1048576
    s_cbranch_scc1 L_FHPOLL
L_FHOK:
    v_lshrrev_b32 v18, v10, v18
    v_lshlrev_b32 v18, 16, v18
    s_mov_b32 s13, 0
L_CPOLL:
    buffer_load_dwordx4 v[48:51], v4, s[48:51], s60 offen offset:0 sc1
    buffer_load_dwordx4 v[52:55], v4, s[48:51], s60 offen offset:1024 sc1
    buffer_load_dwordx4 v[56:59], v4, s[48:51], s60 offen offset:2048 sc1
    buffer_load_dwordx4 v[60:63], v4, s[48:51], s60 offen offset:3072 sc1
    buffer_load_dwordx4 v[64:67], v4, s[48:51], s61 offen offset:0 sc1
    buffer_load_dwordx4 v[68:71], v4, s[48:51], s61 offen offset:1024 sc1
    buffer_load_dwordx4 v[72:75], v4, s[48:51], s61 offen offset:2048 sc1
    s_waitcnt vmcnt(6)
    v_mfma_f32_16x16x32_bf16 v[24:27], v[32:35], v[48:51], 0
    s_waitcnt vmcnt(5)
    v_mfma_f32_16x16x32_bf16 v[24:27], v[32:35], v[52:55], v[24:27]
    s_waitcnt vmcnt(4)
    v_mfma_f32_16x16x32_bf16 v[24:27], v[32:35], v[56:59], v[24:27]
    s_waitcnt vmcnt(3)
    v_mfma_f32_16x16x32_bf16 v[24:27], v[32:35], v[60:63], v[24:27]
    s_waitcnt vmcnt(2)
    v_mfma_f32_16x16x32_bf16 v[24:27], v[32:35], v[64:67], v[24:27]
    s_waitcnt vmcnt(1)
    v_mfma_f32_16x16x32_bf16 v[24:27], v[32:35], v[68:71], v[24:27]
    s_waitcnt vmcnt(0)
    v_mfma_f32_16x16x32_bf16 v[24:27], v[32:35], v[72:75], v[24:27]
    s_add_u32 s13, s13, 1
    s_nop 6
    v_cndmask_b32 v20, v24, v25, s[58:59]
    v_cndmask_b32 v21, v25, v24, s[58:59]
    s_nop 0
    v_add_f32_dpp v22, v20, v21 row_ror:8 row_mask:0xf bank_mask:0xf
    v_cmp_u_f32 vcc, v22, v22
    s_cbranch_vccz L_COK
    s_and_b32 s14, s13, 15
    s_cbranch_scc1 L_CPOLL
    v_max_u32 v20, v48, v49
    v_max3_u32 v20, v20, v50, v51
    v_max3_u32 v20, v20, v52, v53
    v_max3_u32 v20, v20, v54, v55
    v_max3_u32 v20, v20, v56, v57
    v_max3_u32 v20, v20, v58, v59
    v_max3_u32 v20, v20, v60, v61
    v_max3_u32 v20, v20, v62, v63
    v_max3_u32 v20, v20, v64, v65
    v_max3_u32 v20, v20, v66, v67
    v_max3_u32 v20, v20, v68, v69
    v_max3_u32 v20, v20, v70, v71
    v_max3_u32 v20, v20, v72, v73
    v_max3_u32 v20, v20, v74, v75
    v_cmp_eq_u32 vcc, -1, v20
    s_cbranch_vccz L_COK
    s_cmp_lt_u32 s13, 1048576
    s_cbranch_scc1 L_CPOLL
L_COK:
    v_cvt_pk_bf16_f32 v22, v22, v22
    v_lshlrev_b32 v22, 16, v22
    v_add_f32 v22, v18, v22
    v_cvt_pk_bf16_f32 v22, v22, v22
    buffer_store_short v22, v17, s[44:47], s69 offen
    s_endpgm
L_RED:
    s_cmp_ge_u32 s2, 56
    s_cbranch_scc1 L_RED_END
    s_mul_i32 s64, s2, 4682
    s_lshr_b32 s64, s64, 16
    s_mul_i32 s65, s64, 14
    s_sub_u32 s65, s2, s65
    v_lshrrev_b32 v16, 4, v0
    v_and_b32 v17, 7, v0
    v_lshlrev_b32 v18, 5, v16
    v_lshl_add_u32 v18, v17, 1, v18
    s_mul_i32 s69, s64, 896
    s_lshr_b32 s14, s65, 1
    s_lshl_b32 s14, s14, 7
    s_add_u32 s69, s69, s14
    s_and_b32 s14, s65, 1
    s_lshl_b32 s14, s14, 4
    s_add_u32 s69, s69, s14
    buffer_load_ushort v19, v18, s[52:55], s69 offen
    v_mov_b32 v20, 1073741824
    v_bfe_u32 v21, v0, 3, 1
    v_mul_u32_u24 v21, 8192, v21
    v_lshl_add_u32 v21, v16, 4, v21
    v_cmp_eq_u32 vcc, 0, v17
    s_lshl_b32 s70, s2, 7
    s_add_u32 s70, s70, 393216
    v_cndmask_b32 v21, v20, v21, vcc
    s_cmp_eq_u32 s2, 0
    s_cbranch_scc0 L_RED_NOEP
    v_mov_b32 v6, 0
    v_mov_b32 v7, s68
    s_mov_b64 exec, 1
    buffer_store_dword v7, v6, s[48:51], 0 offen sc1
    s_mov_b64 exec, -1
L_RED_NOEP:
    s_lshr_b32 s56, s2, 1
    s_lshl_b32 s56, s56, 14
    s_and_b32 s57, s2, 1
    s_lshl_b32 s57, s57, 12
    s_add_u32 s56, s56, s57
    s_add_u32 s56, s56, 516096
L_wf_64:
    s_sleep 1
    ds_read_b32 v24, v2 offset:44
    s_waitcnt lgkmcnt(0)
    v_readfirstlane_b32 s14, v24
    s_cmp_ge_u32 s14, 1
    s_cbranch_scc0 L_wf_64
    s_lshl_b32 s14, s14, 13
    s_add_u32 s56, s56, s14
    s_waitcnt vmcnt(0)
    v_lshlrev_b32 v19, 16, v19
L_wf_65:
    s_sleep 1
    ds_read_b32 v24, v2 offset:20
    s_waitcnt lgkmcnt(0)
    v_readfirstlane_b32 s14, v24
    s_cmp_ge_u32 s14, 4
    s_cbranch_scc0 L_wf_65
    s_mov_b32 s13, 0
L_rp_66:
    buffer_load_dwordx4 v[32:35], v4, s[48:51], s56 offen offset:0 sc1
    buffer_load_dwordx4 v[36:39], v4, s[48:51], s56 offen offset:1024 sc1
    buffer_load_dwordx4 v[40:43], v4, s[48:51], s56 offen offset:2048 sc1
    buffer_load_dwordx4 v[44:47], v4, s[48:51], s56 offen offset:3072 sc1
    s_waitcnt vmcnt(2)
    v_pk_add_f32 v[64:65], v[32:33], v[36:37]
    v_pk_add_f32 v[66:67], v[34:35], v[38:39]
    s_waitcnt vmcnt(0)
    v_pk_add_f32 v[68:69], v[40:41], v[44:45]
    v_pk_add_f32 v[70:71], v[42:43], v[46:47]
    v_pk_add_f32 v[64:65], v[64:65], v[68:69]
    v_pk_add_f32 v[66:67], v[66:67], v[70:71]
    s_nop 1
    v_permlane16_swap_b32 v64, v65
    v_permlane16_swap_b32 v66, v67
    v_add_f32 v64, v64, v65
    v_add_f32 v66, v66, v67
    s_nop 1
    v_permlane32_swap_b32 v64, v66
    v_add_f32 v64, v64, v66
    s_nop 1
    v_add_f32_dpp v22, v64, v64 row_ror:8 row_mask:0xf bank_mask:0xf
    v_cmp_u_f32 vcc, v22, v22
    s_cbranch_vccz L_rok_67
    s_add_u32 s13, s13, 1
    s_and_b32 s14, s13, 15
    s_cbranch_scc1 L_rp_66
    v_max_u32 v68, v32, v33
    v_max3_u32 v68, v68, v34, v35
    v_max3_u32 v68, v68, v36, v37
    v_max3_u32 v68, v68, v38, v39
    v_max3_u32 v68, v68, v40, v41
    v_max3_u32 v68, v68, v42, v43
    v_max3_u32 v68, v68, v44, v45
    v_max3_u32 v68, v68, v46, v47
    v_cmp_eq_u32 vcc, -1, v68
    s_cbranch_vccz L_rok_67
    s_cmp_lt_u32 s13, 1048576
    s_cbranch_scc1 L_rp_66
L_rok_67:
    v_cvt_pk_bf16_f32 v22, v22, v22
    v_lshlrev_b32 v22, 16, v22
    v_add_f32 v22, v19, v22
    s_nop 1
    v_mov_b32_dpp v23, v22 quad_perm:[1,0,3,2] row_mask:0xf bank_mask:0xf
    v_cvt_pk_bf16_f32 v24, v22, v23
    v_min_u32 v24, -2, v24
    s_nop 1
    v_mov_b32_dpp v25, v24 row_shl:2 row_mask:0xf bank_mask:0xf
    v_mov_b32_dpp v26, v24 row_shl:4 row_mask:0xf bank_mask:0xf
    v_mov_b32_dpp v27, v24 row_shl:6 row_mask:0xf bank_mask:0xf
    buffer_store_dwordx4 v[24:27], v21, s[48:51], s70 offen sc1
    s_add_u32 s70, s70, 16384
    buffer_store_dwordx4 v[24:27], v21, s[48:51], s70 offen sc1
L_RED_END:
    s_endpgm
L_FFN:
    v_lshrrev_b32 v22, 4, v0
    v_bfe_u32 v23, v0, 2, 2
    v_lshl_add_u32 v24, v22, 3, v23
    v_lshlrev_b32 v20, 6, v24
    v_and_b32 v24, 1, v0
    v_lshl_add_u32 v20, v24, 3, v20
    v_and_b32 v24, 1, v22
    v_and_b32 v25, 2, v0
    v_xor_b32 v24, v24, v25
    v_xor_b32 v24, s11, v24
    v_lshl_add_u32 v20, v24, 4, v20
    v_mul_u32_u24 v25, 14336, v25
    v_add_u32 v20, v20, v25
    v_add_u32 v20, 65536, v20
    s_lshl_b32 s14, s11, 13
    s_add_u32 s12, s14, 122880
    v_lshrrev_b32 v24, 2, v0
    v_bfe_u32 v25, v0, 3, 2
    v_and_b32 v26, 3, v0
    v_lshlrev_b32 v24, 7, v24
    v_lshl_add_u32 v24, v26, 3, v24
    v_add_u32 v24, s12, v24
    v_xor_b32 v26, 0, v25
    v_lshl_add_u32 v12, v26, 5, v24
    v_xor_b32 v26, 1, v25
    v_lshl_add_u32 v13, v26, 5, v24
    v_xor_b32 v26, 2, v25
    v_lshl_add_u32 v14, v26, 5, v24
    v_xor_b32 v26, 3, v25
    v_lshl_add_u32 v15, v26, 5, v24
    v_mul_u32_u24 v21, 960, v23
    v_lshl_add_u32 v21, v22, 4, v21
    v_add_u32 v21, 151552, v21
    s_mul_i32 s14, s11, 960
    s_add_u32 s14, s14, 151552
    v_lshrrev_b32 v24, 3, v0
    v_lshlrev_b32 v6, 7, v24
    v_and_b32 v24, 3, v0
    v_lshl_add_u32 v6, v24, 5, v6
    v_bfe_u32 v25, v0, 2, 1
    v_lshl_add_u32 v6, v25, 4, v6
    v_add_u32 v6, s14, v6
    v_lshrrev_b32 v25, 2, v0
    v_lshlrev_b32 v25, 7, v25
    v_lshl_add_u32 v25, v24, 4, v25
    v_max_u32 v5, v5, v25
    v_lshlrev_b32 v24, 6, v23
    v_lshl_add_u32 v24, v22, 4, v24
    v_add_u32 v24, 157824, v24
    v_mov_b32 v25, 158144
    v_and_b32 v26, 3, v0
    v_cmp_eq_u32 vcc, 0, v26
    s_nop 1
    v_cndmask_b32 v16, v25, v24, vcc
    v_cmp_eq_u32 vcc, 1, v26
    s_nop 1
    v_cndmask_b32 v17, v25, v24, vcc
    v_cmp_eq_u32 vcc, 2, v26
    s_nop 1
    v_cndmask_b32 v18, v25, v24, vcc
    v_cmp_eq_u32 vcc, 3, v26
    s_nop 1
    v_cndmask_b32 v19, v25, v24, vcc
    v_and_b32 v24, 15, v0
    v_lshlrev_b32 v7, 6, v22
    v_lshl_add_u32 v7, v24, 1, v7
    s_lshl_b32 s14, s11, 4
    s_add_u32 s14, s14, 157824
    v_add_u32 v7, s14, v7
    v_mov_b32 v25, 158080
    v_cmp_gt_u32 vcc, 8, v24
    s_nop 1
    v_cndmask_b32 v7, v25, v7, vcc
    v_bfe_u32 v26, v0, 3, 1
    v_lshl_add_u32 v25, v22, 3, v26
    v_lshlrev_b32 v25, 14, v25
    v_and_b32 v26, 7, v0
    v_lshl_add_u32 v23, v26, 4, v25
    s_lshl_b32 s69, s11, 15
    s_lshl_b32 s70, s62, 7
    s_add_u32 s69, s69, s70
    s_add_u32 s69, s69, 1048576
    s_add_u32 s70, s69, 8192
L_wf_69:
    s_sleep 1
    ds_read_b32 v24, v2 offset:44
    s_waitcnt lgkmcnt(0)
    v_readfirstlane_b32 s14, v24
    s_cmp_ge_u32 s14, 1
    s_cbranch_scc0 L_wf_69
    s_lshl_b32 s60, s4, 1
    s_and_b32 s60, s60, 2
    s_add_u32 s60, s60, s14
    s_sub_u32 s60, s60, 1
    s_mul_i32 s60, s60, 8192
    s_lshl_b32 s14, s67, 1
    s_add_u32 s60, s60, s14
    s_add_u32 s60, s60, 393216
    s_mov_b32 s61, 0xbfb8aa3b
    buffer_load_dwordx4 v[8:11], v5, s[48:51], s60 offen sc1
    v_mov_b32 v40, 0x3f803f80
    v_mov_b32 v41, 0x3f803f80
    v_mov_b32 v42, 0x3f803f80
    v_mov_b32 v43, 0x3f803f80
    v_mov_b32 v25, 158080
    v_cmp_gt_u32 vcc, 56, v0
    s_lshl_b32 s14, s11, 3
    s_add_u32 s14, s14, 156544
    v_mov_b32 v38, s14
    v_cndmask_b32 v6, v25, v6, vcc
    v_lshlrev_b32 v39, 3, v22
    v_add_u32 v39, 156544, v39
    v_mov_b32 v37, 0x3b124925
    v_mov_b32 v120, 0
    v_mov_b32 v121, 0
    v_mov_b32 v122, 0
    v_mov_b32 v123, 0
    v_mov_b32 v124, 0
    v_mov_b32 v125, 0
    v_mov_b32 v126, 0
    v_mov_b32 v127, 0
    v_mov_b32 v128, 0
    v_mov_b32 v129, 0
    v_mov_b32 v130, 0
    v_mov_b32 v131, 0
    v_mov_b32 v132, 0
    v_mov_b32 v133, 0
    v_mov_b32 v134, 0
    v_mov_b32 v135, 0
L_wf_70:
    s_sleep 1
    ds_read_b32 v24, v2 offset:32
    s_waitcnt lgkmcnt(0)
    v_readfirstlane_b32 s14, v24
    s_cmp_ge_u32 s14, 1
    s_cbranch_scc0 L_wf_70
    ds_read_b64_tr_b16 v[48:49], v20 offset:0
    ds_read_b64_tr_b16 v[50:51], v20 offset:256
    ds_read_b64_tr_b16 v[52:53], v20 offset:2048
    ds_read_b64_tr_b16 v[54:55], v20 offset:2304
    ds_read_b64_tr_b16 v[56:57], v20 offset:4096
    ds_read_b64_tr_b16 v[58:59], v20 offset:4352
    ds_read_b64_tr_b16 v[60:61], v20 offset:6144
    ds_read_b64_tr_b16 v[62:63], v20 offset:6400
    ds_read_b64_tr_b16 v[64:65], v20 offset:8192
    ds_read_b64_tr_b16 v[66:67], v20 offset:8448
    ds_read_b64_tr_b16 v[68:69], v20 offset:10240
    ds_read_b64_tr_b16 v[70:71], v20 offset:10496
    ds_read_b64_tr_b16 v[72:73], v20 offset:12288
    ds_read_b64_tr_b16 v[74:75], v20 offset:12544
    s_waitcnt lgkmcnt(12)
    v_mfma_f32_16x16x32_bf16 v[44:47], v[40:43], v[48:51], 0
    ds_read_b64_tr_b16 v[76:77], v20 offset:14336
    ds_read_b64_tr_b16 v[78:79], v20 offset:14592
    s_waitcnt lgkmcnt(12)
    v_mfma_f32_16x16x32_bf16 v[44:47], v[40:43], v[52:55], v[44:47]
    ds_read_b64_tr_b16 v[80:81], v20 offset:16384
    ds_read_b64_tr_b16 v[82:83], v20 offset:16640
    s_waitcnt lgkmcnt(12)
    v_mfma_f32_16x16x32_bf16 v[44:47], v[40:43], v[56:59], v[44:47]
    ds_read_b64_tr_b16 v[84:85], v20 offset:18432
    ds_read_b64_tr_b16 v[86:87], v20 offset:18688
    s_waitcnt lgkmcnt(12)
    v_mfma_f32_16x16x32_bf16 v[44:47], v[40:43], v[60:63], v[44:47]
    ds_read_b64_tr_b16 v[88:89], v20 offset:20480
    ds_read_b64_tr_b16 v[90:91], v20 offset:20736
    s_waitcnt lgkmcnt(12)
    v_mfma_f32_16x16x32_bf16 v[44:47], v[40:43], v[64:67], v[44:47]
    ds_read_b64_tr_b16 v[92:93], v20 offset:22528
    ds_read_b64_tr_b16 v[94:95], v20 offset:22784
    s_waitcnt lgkmcnt(12)
    v_mfma_f32_16x16x32_bf16 v[44:47], v[40:43], v[68:71], v[44:47]
    ds_read_b64_tr_b16 v[96:97], v20 offset:24576
    ds_read_b64_tr_b16 v[98:99], v20 offset:24832
    s_waitcnt lgkmcnt(12)
    v_mfma_f32_16x16x32_bf16 v[44:47], v[40:43], v[72:75], v[44:47]
    ds_read_b64_tr_b16 v[100:101], v20 offset:26624
    ds_read_b64_tr_b16 v[102:103], v20 offset:26880
    s_waitcnt lgkmcnt(12)
    v_mfma_f32_16x16x32_bf16 v[44:47], v[40:43], v[76:79], v[44:47]
    s_waitcnt lgkmcnt(10)
    v_mfma_f32_16x16x32_bf16 v[44:47], v[40:43], v[80:83], v[44:47]
    s_waitcnt lgkmcnt(8)
    v_mfma_f32_16x16x32_bf16 v[44:47], v[40:43], v[84:87], v[44:47]
    s_waitcnt lgkmcnt(6)
    v_mfma_f32_16x16x32_bf16 v[44:47], v[40:43], v[88:91], v[44:47]
    s_waitcnt lgkmcnt(4)
    v_mfma_f32_16x16x32_bf16 v[44:47], v[40:43], v[92:95], v[44:47]
    s_waitcnt lgkmcnt(2)
    v_mfma_f32_16x16x32_bf16 v[44:47], v[40:43], v[96:99], v[44:47]
    s_waitcnt lgkmcnt(0)
    v_mfma_f32_16x16x32_bf16 v[44:47], v[40:43], v[100:103], v[44:47]
L_wf_71:
    ds_read_b32 v24, v2 offset:32
    s_waitcnt lgkmcnt(0)
    v_readfirstlane_b32 s14, v24
    s_cmp_ge_u32 s14, 2
    s_cbranch_scc0 L_wf_71
    ds_read_b64_tr_b16 v[104:105], v12 offset:0
    ds_read_b64_tr_b16 v[106:107], v12 offset:2048
    ds_read_b64_tr_b16 v[108:109], v13 offset:0
    ds_read_b64_tr_b16 v[110:111], v13 offset:2048
    ds_read_b64_tr_b16 v[112:113], v14 offset:0
    ds_read_b64_tr_b16 v[114:115], v14 offset:2048
    ds_read_b64_tr_b16 v[116:117], v15 offset:0
    ds_read_b64_tr_b16 v[118:119], v15 offset:2048
    s_cmp_eq_u32 s11, 3
    s_cbranch_scc1 L_FFN_P7
    s_waitcnt lgkmcnt(4)
    ds_read_b64_tr_b16 v[120:121], v12 offset:4096
    ds_read_b64_tr_b16 v[122:123], v12 offset:6144
    ds_read_b64_tr_b16 v[124:125], v13 offset:4096
    ds_read_b64_tr_b16 v[126:127], v13 offset:6144
    ds_read_b64_tr_b16 v[128:129], v14 offset:4096
    ds_read_b64_tr_b16 v[130:131], v14 offset:6144
    ds_read_b64_tr_b16 v[132:133], v15 offset:4096
    ds_read_b64_tr_b16 v[134:135], v15 offset:6144
L_FFN_P7:
    s_mov_b32 s13, 0
L_HPOLL:
    buffer_load_dwordx4 v[8:11], v5, s[48:51], s60 offen sc1
    s_waitcnt vmcnt(0)
    v_max3_u32 v24, v8, v9, v10
    v_max_u32 v24, v24, v11
    v_cmp_eq_u32 vcc, -1, v24
    s_cbranch_vccz L_HOK
    s_add_u32 s13, s13, 1
    s_cmp_lt_u32 s13, 1048576
    s_cbranch_scc1 L_HPOLL
L_HOK:
    ds_write_b128 v6, v[8:11]
    v_dot2_f32_bf16 v32, v8, v8, 0
    v_dot2_f32_bf16 v33, v8, v40, 0
    v_dot2_f32_bf16 v32, v9, v9, v32
    v_dot2_f32_bf16 v33, v9, v40, v33
    v_dot2_f32_bf16 v32, v10, v10, v32
    v_dot2_f32_bf16 v33, v10, v40, v33
    v_dot2_f32_bf16 v32, v11, v11, v32
    v_dot2_f32_bf16 v33, v11, v40, v33
    s_waitcnt lgkmcnt(0)
    s_barrier
    ds_read_b128 v[136:139], v21 offset:0
    ds_read_b128 v[140:143], v21 offset:64
    v_add_f32_dpp v32, v32, v32 row_shr:1 row_mask:0xf bank_mask:0xf
    v_add_f32_dpp v33, v33, v33 row_shr:1 row_mask:0xf bank_mask:0xf
    ds_read_b128 v[144:147], v21 offset:128
    ds_read_b128 v[148:151], v21 offset:192
    v_add_f32_dpp v32, v32, v32 row_shr:2 row_mask:0xf bank_mask:0xf
    v_add_f32_dpp v33, v33, v33 row_shr:2 row_mask:0xf bank_mask:0xf
    ds_read_b128 v[152:155], v21 offset:256
    ds_read_b128 v[156:159], v21 offset:320
    v_add_f32_dpp v32, v32, v32 row_shr:4 row_mask:0xf bank_mask:0xf
    v_add_f32_dpp v33, v33, v33 row_shr:4 row_mask:0xf bank_mask:0xf
    ds_read_b128 v[160:163], v21 offset:384
    ds_read_b128 v[164:167], v21 offset:448
    v_add_f32_dpp v32, v32, v32 row_shr:8 row_mask:0xf bank_mask:0xf
    v_add_f32_dpp v33, v33, v33 row_shr:8 row_mask:0xf bank_mask:0xf
    ds_read_b128 v[168:171], v21 offset:512
    ds_read_b128 v[172:175], v21 offset:576
    v_add_f32_dpp v32, v32, v32 row_bcast:15 row_mask:0xa bank_mask:0xf
    v_add_f32_dpp v33, v33, v33 row_bcast:15 row_mask:0xa bank_mask:0xf
    ds_read_b128 v[176:179], v21 offset:640
    ds_read_b128 v[180:183], v21 offset:704
    v_add_f32_dpp v32, v32, v32 row_bcast:31 row_mask:0xc bank_mask:0xf
    v_add_f32_dpp v33, v33, v33 row_bcast:31 row_mask:0xc bank_mask:0xf
    ds_read_b128 v[184:187], v21 offset:768
    ds_read_b128 v[188:191], v21 offset:832
    v_readlane_b32 s58, v32, 63
    v_readlane_b32 s57, v33, 63
    s_waitcnt lgkmcnt(13)
    v_mfma_f32_16x16x32_bf16 v[24:27], v[136:139], v[48:51], 0
    v_mul_f32 v35, s58, v37
    v_mul_f32 v34, s57, v37
    v_fma_f32 v35, -v34, v34, v35
    s_waitcnt lgkmcnt(12)
    v_mfma_f32_16x16x32_bf16 v[24:27], v[140:143], v[52:55], v[24:27]
    v_max_f32 v35, 0, v35
    v_cvt_pk_bf16_f32 v36, v34, v35
    v_and_b32 v35, 0xffff0000, v36
    s_waitcnt lgkmcnt(11)
    v_mfma_f32_16x16x32_bf16 v[24:27], v[144:147], v[56:59], v[24:27]
    v_lshlrev_b32 v34, 16, v36
    v_add_f32 v35, 0x3727c5ac, v35
    v_cvt_pk_bf16_f32 v35, v35, v35
    s_waitcnt lgkmcnt(10)
    v_mfma_f32_16x16x32_bf16 v[24:27], v[148:151], v[60:63], v[24:27]
    v_lshlrev_b32 v35, 16, v35
    v_sqrt_f32 v35, v35
    s_waitcnt lgkmcnt(9)
    v_mfma_f32_16x16x32_bf16 v[24:27], v[152:155], v[64:67], v[24:27]
    v_cvt_pk_bf16_f32 v35, v35, v35
    v_lshlrev_b32 v35, 16, v35
    v_rcp_f32 v35, v35
    s_waitcnt lgkmcnt(8)
    v_mfma_f32_16x16x32_bf16 v[24:27], v[156:159], v[68:71], v[24:27]
    ds_write_b64 v38, v[34:35]
    s_waitcnt lgkmcnt(8)
    v_mfma_f32_16x16x32_bf16 v[24:27], v[160:163], v[72:75], v[24:27]
    s_waitcnt lgkmcnt(7)
    v_mfma_f32_16x16x32_bf16 v[24:27], v[164:167], v[76:79], v[24:27]
    s_waitcnt lgkmcnt(6)
    v_mfma_f32_16x16x32_bf16 v[24:27], v[168:171], v[80:83], v[24:27]
    s_waitcnt lgkmcnt(5)
    v_mfma_f32_16x16x32_bf16 v[24:27], v[172:175], v[84:87], v[24:27]
    s_waitcnt lgkmcnt(0)
    s_barrier
    ds_read_b64 v[34:35], v39
    v_mfma_f32_16x16x32_bf16 v[24:27], v[176:179], v[88:91], v[24:27]
    v_mfma_f32_16x16x32_bf16 v[24:27], v[180:183], v[92:95], v[24:27]
    v_mfma_f32_16x16x32_bf16 v[24:27], v[184:187], v[96:99], v[24:27]
    v_mfma_f32_16x16x32_bf16 v[24:27], v[188:191], v[100:103], v[24:27]
    s_nop 6
    s_waitcnt lgkmcnt(0)
    v_fma_f32 v28, -v34, v44, v24
    v_mul_f32 v28, v28, v35
    v_cvt_pk_bf16_f32 v28, v28, v28
    v_lshlrev_b32 v28, 16, v28
    v_mul_f32 v29, s61, v28
    v_exp_f32 v29, v29
    v_mov_b32_dpp v30, v28 row_ror:8 row_mask:0xf bank_mask:0xf
    v_add_f32 v29, 1.0, v29
    v_rcp_f32 v29, v29
    s_nop 0
    v_mul_f32 v29, v28, v29
    v_cvt_pk_bf16_f32 v29, v29, v29
    v_lshlrev_b32 v29, 16, v29
    v_mul_f32 v29, v29, v30
    v_cvt_pk_bf16_f32 v29, v29, v29
    ds_write_b16 v7, v29
    s_waitcnt lgkmcnt(0)
    s_barrier
    ds_read_b128 v[136:139], v16
    ds_read_b128 v[140:143], v17
    ds_read_b128 v[144:147], v18
    ds_read_b128 v[148:151], v19
    s_waitcnt lgkmcnt(3)
    v_mfma_f32_16x16x32_bf16 v[24:27], v[136:139], v[104:107], 0
    s_waitcnt lgkmcnt(2)
    v_mfma_f32_16x16x32_bf16 v[24:27], v[140:143], v[108:111], v[24:27]
    s_waitcnt lgkmcnt(1)
    v_mfma_f32_16x16x32_bf16 v[24:27], v[144:147], v[112:115], v[24:27]
    s_waitcnt lgkmcnt(0)
    v_mfma_f32_16x16x32_bf16 v[24:27], v[148:151], v[116:119], v[24:27]
    v_mfma_f32_16x16x32_bf16 v[28:31], v[136:139], v[120:123], 0
    v_mfma_f32_16x16x32_bf16 v[28:31], v[140:143], v[124:127], v[28:31]
    v_mfma_f32_16x16x32_bf16 v[28:31], v[144:147], v[128:131], v[28:31]
    v_mfma_f32_16x16x32_bf16 v[28:31], v[148:151], v[132:135], v[28:31]
    s_nop 3
    v_cvt_pk_bf16_f32 v32, v24, v25
    v_cvt_pk_bf16_f32 v33, v26, v27
    v_min_u32 v32, -2, v32
    v_min_u32 v33, -2, v33
    v_cvt_pk_bf16_f32 v34, v28, v29
    v_cvt_pk_bf16_f32 v35, v30, v31
    v_min_u32 v34, -2, v34
    v_min_u32 v35, -2, v35
    buffer_store_dwordx4 v[32:35], v23, s[48:51], s69 offen sc1
    buffer_store_dwordx4 v[32:35], v23, s[48:51], s70 offen sc1
    s_endpgm
L_END:
    s_endpgm

.section .rodata,"a"
.p2align 6
.amdhsa_kernel sequential_preLN__sliding_block_cached__swiglu_ffn__decode_kernel
  .amdhsa_next_free_vgpr 192
  .amdhsa_next_free_sgpr 96
  .amdhsa_accum_offset 192
  .amdhsa_group_segment_fixed_size 0
  .amdhsa_kernarg_size 96
  .amdhsa_user_sgpr_count 2
  .amdhsa_user_sgpr_kernarg_segment_ptr 1
  .amdhsa_system_sgpr_workgroup_id_x 1
  .amdhsa_float_denorm_mode_32 3
.end_amdhsa_kernel
```
